```python
import torch

def _softmax(x, axis=-1):
    return torch.softmax(x, dim=axis)
def _gelu(x):
    return torch.nn.functional.gelu(x, approximate="tanh")
def _silu(x):
    return torch.nn.functional.silu(x)
def _sigmoid(x):
    return torch.sigmoid(x)
def _layernorm(x, axis=-1, eps=1e-5):
    m = x.mean(dim=axis, keepdim=True)
    v = x.var(dim=axis, keepdim=True, unbiased=False)
    return (x - m) / torch.sqrt(v + eps)
def _scatter_add(tgt, idx, src, axis=0):
    return tgt.clone().index_add_(axis, idx, src)
def _segment_sum(src, seg, n):
    out = torch.zeros((n,) + src.shape[1:], dtype=src.dtype)
    return out.index_add_(0, seg, src)
def _pad(x, pw):
    flat = tuple(v for pair in reversed(pw) for v in pair)
    return torch.nn.functional.pad(x, flat)

kernel_name = 'parallel_sum__ssm_conv_h3__glu_gated_glu__prompt'

def setup_inputs():

    _w = (lambda a: (lambda t: t.to(torch.bfloat16) if t.is_floating_point() else t)(torch.as_tensor(a)))
    def _A_setup():
        B, S, D = 1, 2048, 640
        ks = 4
        return {
            "q": _w((lambda *s: torch.randn(*s, dtype=torch.bfloat16) * 0.05)(B, S, D)),
            "k": _w((lambda *s: torch.randn(*s, dtype=torch.bfloat16) * 0.4)(B, S, D)),
            "v": _w((lambda *s: torch.randn(*s, dtype=torch.bfloat16) * 0.4)(B, S, D)),
            "shift_k": _w((lambda *s: torch.randn(*s, dtype=torch.bfloat16) * 0.4)(D, ks) * 0.5),
            "ssm_k": _w((lambda *s: torch.randn(*s, dtype=torch.bfloat16) * 1.6)(D, S) * (1.0 / S ** 0.5)),
            "ssm_D": _w((lambda *s: torch.randn(*s, dtype=torch.bfloat16) * 0.4)(D)),
        }
    _A_in = _A_setup()

    def _B_setup():
        B, S, D, F = 1, 2048, 640, 1728
        return {
            "x": _w((lambda *s: torch.randn(*s, dtype=torch.bfloat16) * 0.05)(B, S, D)),
            "w_gate": _w((lambda *s: torch.randn(*s, dtype=torch.bfloat16) * 0.05)(D, F)),
            "w_up": _w((lambda *s: torch.randn(*s, dtype=torch.bfloat16) * 0.05)(D, F)),
            "w_down": _w((lambda *s: torch.randn(*s, dtype=torch.bfloat16) * 0.05)(F, D)),
        }
    _B_in = _B_setup()

    return {
        "A_q": _A_in["q"],
        "A_k": _A_in["k"],
        "A_v": _A_in["v"],
        "A_shift_k": _A_in["shift_k"],
        "A_ssm_k": _A_in["ssm_k"],
        "A_ssm_D": _A_in["ssm_D"],
        "B_x": _B_in["x"],
        "B_w_gate": _B_in["w_gate"],
        "B_w_up": _B_in["w_up"],
        "B_w_down": _B_in["w_down"],
    }

def reference(A_q, A_k, A_v, A_shift_k, A_ssm_k, A_ssm_D, B_x, B_w_gate, B_w_up, B_w_down):
    def _A_ref(q, k, v, shift_k, ssm_k, ssm_D):
        B, S, D = q.shape
        ks = shift_k.shape[-1]
        k_pad = _pad(k, ((0, 0), (ks - 1, 0), (0, 0)))
        k_shift = torch.zeros_like(k)
        for t in range(ks):
            k_shift = k_shift + k_pad[:, t:t + S, :] * shift_k[:, ks - 1 - t][None, None, :]
        kv = k_shift * v
        L = 2 * S
        kv_pad = _pad(kv, ((0, 0), (0, S), (0, 0)))
        kf_pad = _pad(ssm_k, ((0, 0), (0, S)))
        kv_f = (lambda x, axes=(-2,-1): torch.fft.rfft2(x.float(), dim=axes))(kv_pad[:, None, :, :], axes=(1, 2))
        kf_f = (lambda x, axes=(-2,-1): torch.fft.rfft2(x.float(), dim=axes))(kf_pad[:, None, :], axes=(1, 2))
        kf_f = (lambda x, *d: x.permute(*d))(kf_f, 1, 2, 0)
        y_f = kv_f * kf_f[None, :, :, :]
        y = (lambda x, s, axes=(-2,-1): torch.fft.irfft2(x, s=s, dim=axes).to(torch.bfloat16))(y_f, (1, L), axes=(1, 2))[:, 0, :S, :]
        y = y + kv * ssm_D[None, None, :]
        return q * y

    def _B_ref(x, w_gate, w_up, w_down):
        g = torch.einsum("bsd,df->bsf", x, w_gate)
        u = torch.einsum("bsd,df->bsf", x, w_up)
        h = _sigmoid(g) * u
        return torch.einsum("bsf,fd->bsd", h, w_down)

    x = A_q
    xn = _layernorm(x, axis=-1)
    return x + _A_ref(xn, A_k, A_v, A_shift_k, A_ssm_k, A_ssm_D) + _B_ref(xn, B_w_gate, B_w_up, B_w_down)
```

```asm
; @launch kernel=prep_kernel grid=(1258,1,1) block=(256,1,1) lds=9216
; @launch kernel=mix_kernel grid=(1080,1,1) block=(256,1,1) lds=65536
; @launch kernel=gemm2_kernel grid=(160,1,1) block=(256,1,1) lds=98304
.amdgcn_target "amdgcn-amd-amdhsa--gfx950"
.text
.globl prep_kernel
.p2align 8
.type prep_kernel,@function
prep_kernel:
    s_mov_b32 s33, s2
    s_load_dwordx16 s[36:51], s[0:1], 0
    s_load_dwordx4 s[52:55], s[0:1], 64
    s_load_dwordx2 s[56:57], s[0:1], 96
    s_cmp_ge_u32 s33, 1258
    s_cbranch_scc1 prep_end
    s_waitcnt lgkmcnt(0)
    s_cmp_ge_u32 s33, 128
    s_cbranch_scc1 prep_jobB
    s_mov_b32 s8, s36
    s_mov_b32 s9, s37
    s_mov_b32 s10, 2621440
    s_mov_b32 s11, 0x00020000
    s_mov_b32 s12, s56
    s_mov_b32 s13, s57
    s_mov_b32 s14, 2621440
    s_mov_b32 s15, 0x00020000
    s_lshl_b32 s3, s33, 4
    v_lshrrev_b32 v1, 4, v0
    v_add_u32 v1, s3, v1
    v_mul_u32_u24 v1, 1280, v1
    v_and_b32 v2, 15, v0
    v_lshlrev_b32 v2, 4, v2
    v_add_u32 v1, v1, v2
    buffer_load_dwordx4 v[8:11], v1, s[8:11], 0 offen offset:0
    buffer_load_dwordx4 v[12:15], v1, s[8:11], 0 offen offset:256
    buffer_load_dwordx4 v[16:19], v1, s[8:11], 0 offen offset:512
    buffer_load_dwordx4 v[20:23], v1, s[8:11], 0 offen offset:768
    buffer_load_dwordx4 v[24:27], v1, s[8:11], 0 offen offset:1024
    s_waitcnt vmcnt(0)
    v_lshlrev_b32 v32, 16, v8
    v_and_b32 v33, 0xffff0000, v8
    v_lshlrev_b32 v34, 16, v9
    v_and_b32 v35, 0xffff0000, v9
    v_lshlrev_b32 v36, 16, v10
    v_and_b32 v37, 0xffff0000, v10
    v_lshlrev_b32 v38, 16, v11
    v_and_b32 v39, 0xffff0000, v11
    v_lshlrev_b32 v40, 16, v12
    v_and_b32 v41, 0xffff0000, v12
    v_lshlrev_b32 v42, 16, v13
    v_and_b32 v43, 0xffff0000, v13
    v_lshlrev_b32 v44, 16, v14
    v_and_b32 v45, 0xffff0000, v14
    v_lshlrev_b32 v46, 16, v15
    v_and_b32 v47, 0xffff0000, v15
    v_lshlrev_b32 v48, 16, v16
    v_and_b32 v49, 0xffff0000, v16
    v_lshlrev_b32 v50, 16, v17
    v_and_b32 v51, 0xffff0000, v17
    v_lshlrev_b32 v52, 16, v18
    v_and_b32 v53, 0xffff0000, v18
    v_lshlrev_b32 v54, 16, v19
    v_and_b32 v55, 0xffff0000, v19
    v_lshlrev_b32 v56, 16, v20
    v_and_b32 v57, 0xffff0000, v20
    v_lshlrev_b32 v58, 16, v21
    v_and_b32 v59, 0xffff0000, v21
    v_lshlrev_b32 v60, 16, v22
    v_and_b32 v61, 0xffff0000, v22
    v_lshlrev_b32 v62, 16, v23
    v_and_b32 v63, 0xffff0000, v23
    v_lshlrev_b32 v64, 16, v24
    v_and_b32 v65, 0xffff0000, v24
    v_lshlrev_b32 v66, 16, v25
    v_and_b32 v67, 0xffff0000, v25
    v_lshlrev_b32 v68, 16, v26
    v_and_b32 v69, 0xffff0000, v26
    v_lshlrev_b32 v70, 16, v27
    v_and_b32 v71, 0xffff0000, v27
    v_add_f32 v4, v32, v33
    v_add_f32 v4, v4, v34
    v_add_f32 v4, v4, v35
    v_add_f32 v4, v4, v36
    v_add_f32 v4, v4, v37
    v_add_f32 v4, v4, v38
    v_add_f32 v4, v4, v39
    v_add_f32 v4, v4, v40
    v_add_f32 v4, v4, v41
    v_add_f32 v4, v4, v42
    v_add_f32 v4, v4, v43
    v_add_f32 v4, v4, v44
    v_add_f32 v4, v4, v45
    v_add_f32 v4, v4, v46
    v_add_f32 v4, v4, v47
    v_add_f32 v4, v4, v48
    v_add_f32 v4, v4, v49
    v_add_f32 v4, v4, v50
    v_add_f32 v4, v4, v51
    v_add_f32 v4, v4, v52
    v_add_f32 v4, v4, v53
    v_add_f32 v4, v4, v54
    v_add_f32 v4, v4, v55
    v_add_f32 v4, v4, v56
    v_add_f32 v4, v4, v57
    v_add_f32 v4, v4, v58
    v_add_f32 v4, v4, v59
    v_add_f32 v4, v4, v60
    v_add_f32 v4, v4, v61
    v_add_f32 v4, v4, v62
    v_add_f32 v4, v4, v63
    v_add_f32 v4, v4, v64
    v_add_f32 v4, v4, v65
    v_add_f32 v4, v4, v66
    v_add_f32 v4, v4, v67
    v_add_f32 v4, v4, v68
    v_add_f32 v4, v4, v69
    v_add_f32 v4, v4, v70
    v_add_f32 v4, v4, v71
    s_nop 1
    v_add_f32_dpp v4, v4, v4 row_ror:8 row_mask:0xf bank_mask:0xf
    s_nop 1
    v_add_f32_dpp v4, v4, v4 row_ror:4 row_mask:0xf bank_mask:0xf
    s_nop 1
    v_add_f32_dpp v4, v4, v4 row_ror:2 row_mask:0xf bank_mask:0xf
    s_nop 1
    v_add_f32_dpp v4, v4, v4 row_ror:1 row_mask:0xf bank_mask:0xf
    v_mul_f32 v4, 0x3acccccd, v4
    v_sub_f32 v5, v32, v4
    v_mul_f32 v6, v5, v5
    v_sub_f32 v5, v33, v4
    v_fmac_f32 v6, v5, v5
    v_sub_f32 v5, v34, v4
    v_fmac_f32 v6, v5, v5
    v_sub_f32 v5, v35, v4
    v_fmac_f32 v6, v5, v5
    v_sub_f32 v5, v36, v4
    v_fmac_f32 v6, v5, v5
    v_sub_f32 v5, v37, v4
    v_fmac_f32 v6, v5, v5
    v_sub_f32 v5, v38, v4
    v_fmac_f32 v6, v5, v5
    v_sub_f32 v5, v39, v4
    v_fmac_f32 v6, v5, v5
    v_sub_f32 v5, v40, v4
    v_fmac_f32 v6, v5, v5
    v_sub_f32 v5, v41, v4
    v_fmac_f32 v6, v5, v5
    v_sub_f32 v5, v42, v4
    v_fmac_f32 v6, v5, v5
    v_sub_f32 v5, v43, v4
    v_fmac_f32 v6, v5, v5
    v_sub_f32 v5, v44, v4
    v_fmac_f32 v6, v5, v5
    v_sub_f32 v5, v45, v4
    v_fmac_f32 v6, v5, v5
    v_sub_f32 v5, v46, v4
    v_fmac_f32 v6, v5, v5
    v_sub_f32 v5, v47, v4
    v_fmac_f32 v6, v5, v5
    v_sub_f32 v5, v48, v4
    v_fmac_f32 v6, v5, v5
    v_sub_f32 v5, v49, v4
    v_fmac_f32 v6, v5, v5
    v_sub_f32 v5, v50, v4
    v_fmac_f32 v6, v5, v5
    v_sub_f32 v5, v51, v4
    v_fmac_f32 v6, v5, v5
    v_sub_f32 v5, v52, v4
    v_fmac_f32 v6, v5, v5
    v_sub_f32 v5, v53, v4
    v_fmac_f32 v6, v5, v5
    v_sub_f32 v5, v54, v4
    v_fmac_f32 v6, v5, v5
    v_sub_f32 v5, v55, v4
    v_fmac_f32 v6, v5, v5
    v_sub_f32 v5, v56, v4
    v_fmac_f32 v6, v5, v5
    v_sub_f32 v5, v57, v4
    v_fmac_f32 v6, v5, v5
    v_sub_f32 v5, v58, v4
    v_fmac_f32 v6, v5, v5
    v_sub_f32 v5, v59, v4
    v_fmac_f32 v6, v5, v5
    v_sub_f32 v5, v60, v4
    v_fmac_f32 v6, v5, v5
    v_sub_f32 v5, v61, v4
    v_fmac_f32 v6, v5, v5
    v_sub_f32 v5, v62, v4
    v_fmac_f32 v6, v5, v5
    v_sub_f32 v5, v63, v4
    v_fmac_f32 v6, v5, v5
    v_sub_f32 v5, v64, v4
    v_fmac_f32 v6, v5, v5
    v_sub_f32 v5, v65, v4
    v_fmac_f32 v6, v5, v5
    v_sub_f32 v5, v66, v4
    v_fmac_f32 v6, v5, v5
    v_sub_f32 v5, v67, v4
    v_fmac_f32 v6, v5, v5
    v_sub_f32 v5, v68, v4
    v_fmac_f32 v6, v5, v5
    v_sub_f32 v5, v69, v4
    v_fmac_f32 v6, v5, v5
    v_sub_f32 v5, v70, v4
    v_fmac_f32 v6, v5, v5
    v_sub_f32 v5, v71, v4
    v_fmac_f32 v6, v5, v5
    s_nop 1
    v_add_f32_dpp v6, v6, v6 row_ror:8 row_mask:0xf bank_mask:0xf
    s_nop 1
    v_add_f32_dpp v6, v6, v6 row_ror:4 row_mask:0xf bank_mask:0xf
    s_nop 1
    v_add_f32_dpp v6, v6, v6 row_ror:2 row_mask:0xf bank_mask:0xf
    s_nop 1
    v_add_f32_dpp v6, v6, v6 row_ror:1 row_mask:0xf bank_mask:0xf
    v_mul_f32 v6, 0x3acccccd, v6
    v_cvt_pk_bf16_f32 v4, v4, v4
    v_lshlrev_b32 v4, 16, v4
    v_cvt_pk_bf16_f32 v6, v6, v6
    v_lshlrev_b32 v6, 16, v6
    v_add_f32 v6, 0x3727c5ac, v6
    v_cvt_pk_bf16_f32 v6, v6, v6
    v_lshlrev_b32 v6, 16, v6
    v_sqrt_f32 v6, v6
    s_nop 0
    v_cvt_pk_bf16_f32 v6, v6, v6
    v_lshlrev_b32 v6, 16, v6
    v_rcp_f32 v7, v6
    s_nop 0
    v_sub_f32 v28, v32, v4
    v_sub_f32 v29, v33, v4
    v_cvt_pk_bf16_f32 v30, v28, v29
    v_lshlrev_b32 v28, 16, v30
    v_and_b32 v29, 0xffff0000, v30
    v_mul_f32 v28, v28, v7
    v_mul_f32 v29, v29, v7
    v_cvt_pk_bf16_f32 v8, v28, v29
    v_sub_f32 v28, v34, v4
    v_sub_f32 v29, v35, v4
    v_cvt_pk_bf16_f32 v30, v28, v29
    v_lshlrev_b32 v28, 16, v30
    v_and_b32 v29, 0xffff0000, v30
    v_mul_f32 v28, v28, v7
    v_mul_f32 v29, v29, v7
    v_cvt_pk_bf16_f32 v9, v28, v29
    v_sub_f32 v28, v36, v4
    v_sub_f32 v29, v37, v4
    v_cvt_pk_bf16_f32 v30, v28, v29
    v_lshlrev_b32 v28, 16, v30
    v_and_b32 v29, 0xffff0000, v30
    v_mul_f32 v28, v28, v7
    v_mul_f32 v29, v29, v7
    v_cvt_pk_bf16_f32 v10, v28, v29
    v_sub_f32 v28, v38, v4
    v_sub_f32 v29, v39, v4
    v_cvt_pk_bf16_f32 v30, v28, v29
    v_lshlrev_b32 v28, 16, v30
    v_and_b32 v29, 0xffff0000, v30
    v_mul_f32 v28, v28, v7
    v_mul_f32 v29, v29, v7
    v_cvt_pk_bf16_f32 v11, v28, v29
    v_sub_f32 v28, v40, v4
    v_sub_f32 v29, v41, v4
    v_cvt_pk_bf16_f32 v30, v28, v29
    v_lshlrev_b32 v28, 16, v30
    v_and_b32 v29, 0xffff0000, v30
    v_mul_f32 v28, v28, v7
    v_mul_f32 v29, v29, v7
    v_cvt_pk_bf16_f32 v12, v28, v29
    v_sub_f32 v28, v42, v4
    v_sub_f32 v29, v43, v4
    v_cvt_pk_bf16_f32 v30, v28, v29
    v_lshlrev_b32 v28, 16, v30
    v_and_b32 v29, 0xffff0000, v30
    v_mul_f32 v28, v28, v7
    v_mul_f32 v29, v29, v7
    v_cvt_pk_bf16_f32 v13, v28, v29
    v_sub_f32 v28, v44, v4
    v_sub_f32 v29, v45, v4
    v_cvt_pk_bf16_f32 v30, v28, v29
    v_lshlrev_b32 v28, 16, v30
    v_and_b32 v29, 0xffff0000, v30
    v_mul_f32 v28, v28, v7
    v_mul_f32 v29, v29, v7
    v_cvt_pk_bf16_f32 v14, v28, v29
    v_sub_f32 v28, v46, v4
    v_sub_f32 v29, v47, v4
    v_cvt_pk_bf16_f32 v30, v28, v29
    v_lshlrev_b32 v28, 16, v30
    v_and_b32 v29, 0xffff0000, v30
    v_mul_f32 v28, v28, v7
    v_mul_f32 v29, v29, v7
    v_cvt_pk_bf16_f32 v15, v28, v29
    v_sub_f32 v28, v48, v4
    v_sub_f32 v29, v49, v4
    v_cvt_pk_bf16_f32 v30, v28, v29
    v_lshlrev_b32 v28, 16, v30
    v_and_b32 v29, 0xffff0000, v30
    v_mul_f32 v28, v28, v7
    v_mul_f32 v29, v29, v7
    v_cvt_pk_bf16_f32 v16, v28, v29
    v_sub_f32 v28, v50, v4
    v_sub_f32 v29, v51, v4
    v_cvt_pk_bf16_f32 v30, v28, v29
    v_lshlrev_b32 v28, 16, v30
    v_and_b32 v29, 0xffff0000, v30
    v_mul_f32 v28, v28, v7
    v_mul_f32 v29, v29, v7
    v_cvt_pk_bf16_f32 v17, v28, v29
    v_sub_f32 v28, v52, v4
    v_sub_f32 v29, v53, v4
    v_cvt_pk_bf16_f32 v30, v28, v29
    v_lshlrev_b32 v28, 16, v30
    v_and_b32 v29, 0xffff0000, v30
    v_mul_f32 v28, v28, v7
    v_mul_f32 v29, v29, v7
    v_cvt_pk_bf16_f32 v18, v28, v29
    v_sub_f32 v28, v54, v4
    v_sub_f32 v29, v55, v4
    v_cvt_pk_bf16_f32 v30, v28, v29
    v_lshlrev_b32 v28, 16, v30
    v_and_b32 v29, 0xffff0000, v30
    v_mul_f32 v28, v28, v7
    v_mul_f32 v29, v29, v7
    v_cvt_pk_bf16_f32 v19, v28, v29
    v_sub_f32 v28, v56, v4
    v_sub_f32 v29, v57, v4
    v_cvt_pk_bf16_f32 v30, v28, v29
    v_lshlrev_b32 v28, 16, v30
    v_and_b32 v29, 0xffff0000, v30
    v_mul_f32 v28, v28, v7
    v_mul_f32 v29, v29, v7
    v_cvt_pk_bf16_f32 v20, v28, v29
    v_sub_f32 v28, v58, v4
    v_sub_f32 v29, v59, v4
    v_cvt_pk_bf16_f32 v30, v28, v29
    v_lshlrev_b32 v28, 16, v30
    v_and_b32 v29, 0xffff0000, v30
    v_mul_f32 v28, v28, v7
    v_mul_f32 v29, v29, v7
    v_cvt_pk_bf16_f32 v21, v28, v29
    v_sub_f32 v28, v60, v4
    v_sub_f32 v29, v61, v4
    v_cvt_pk_bf16_f32 v30, v28, v29
    v_lshlrev_b32 v28, 16, v30
    v_and_b32 v29, 0xffff0000, v30
    v_mul_f32 v28, v28, v7
    v_mul_f32 v29, v29, v7
    v_cvt_pk_bf16_f32 v22, v28, v29
    v_sub_f32 v28, v62, v4
    v_sub_f32 v29, v63, v4
    v_cvt_pk_bf16_f32 v30, v28, v29
    v_lshlrev_b32 v28, 16, v30
    v_and_b32 v29, 0xffff0000, v30
    v_mul_f32 v28, v28, v7
    v_mul_f32 v29, v29, v7
    v_cvt_pk_bf16_f32 v23, v28, v29
    v_sub_f32 v28, v64, v4
    v_sub_f32 v29, v65, v4
    v_cvt_pk_bf16_f32 v30, v28, v29
    v_lshlrev_b32 v28, 16, v30
    v_and_b32 v29, 0xffff0000, v30
    v_mul_f32 v28, v28, v7
    v_mul_f32 v29, v29, v7
    v_cvt_pk_bf16_f32 v24, v28, v29
    v_sub_f32 v28, v66, v4
    v_sub_f32 v29, v67, v4
    v_cvt_pk_bf16_f32 v30, v28, v29
    v_lshlrev_b32 v28, 16, v30
    v_and_b32 v29, 0xffff0000, v30
    v_mul_f32 v28, v28, v7
    v_mul_f32 v29, v29, v7
    v_cvt_pk_bf16_f32 v25, v28, v29
    v_sub_f32 v28, v68, v4
    v_sub_f32 v29, v69, v4
    v_cvt_pk_bf16_f32 v30, v28, v29
    v_lshlrev_b32 v28, 16, v30
    v_and_b32 v29, 0xffff0000, v30
    v_mul_f32 v28, v28, v7
    v_mul_f32 v29, v29, v7
    v_cvt_pk_bf16_f32 v26, v28, v29
    v_sub_f32 v28, v70, v4
    v_sub_f32 v29, v71, v4
    v_cvt_pk_bf16_f32 v30, v28, v29
    v_lshlrev_b32 v28, 16, v30
    v_and_b32 v29, 0xffff0000, v30
    v_mul_f32 v28, v28, v7
    v_mul_f32 v29, v29, v7
    v_cvt_pk_bf16_f32 v27, v28, v29
    buffer_store_dwordx4 v[8:11], v1, s[12:15], 0 offen offset:0
    buffer_store_dwordx4 v[12:15], v1, s[12:15], 0 offen offset:256
    buffer_store_dwordx4 v[16:19], v1, s[12:15], 0 offen offset:512
    buffer_store_dwordx4 v[20:23], v1, s[12:15], 0 offen offset:768
    buffer_store_dwordx4 v[24:27], v1, s[12:15], 0 offen offset:1024
    s_branch prep_end
prep_jobB:
    s_cmp_ge_u32 s33, 448
    s_cbranch_scc1 prep_jobC
    s_sub_u32 s3, s33, 128
    s_mul_i32 s4, s3, 205
    s_lshr_b32 s4, s4, 11
    s_mul_i32 s6, s4, 10
    s_sub_u32 s5, s3, s6
    s_mov_b32 s8, s38
    s_mov_b32 s9, s39
    s_mov_b32 s10, 2621440
    s_mov_b32 s11, 0x00020000
    s_mov_b32 s12, s40
    s_mov_b32 s13, s41
    s_mov_b32 s14, 2621440
    s_mov_b32 s15, 0x00020000
    s_mov_b32 s16, s42
    s_mov_b32 s17, s43
    s_mov_b32 s18, 5120
    s_mov_b32 s19, 0x00020000
    s_add_u32 s20, s56, 2621440
    s_addc_u32 s21, s57, 0
    s_mov_b32 s22, 2621440
    s_mov_b32 s23, 0x00020000
    s_lshl_b32 s4, s4, 6
    s_lshl_b32 s5, s5, 6
    v_and_b32 v2, 7, v0
    v_lshlrev_b32 v3, 3, v2
    v_add_u32 v3, s5, v3
    v_lshlrev_b32 v4, 3, v3
    buffer_load_dwordx4 v[96:99], v4, s[16:19], 0 offen offset:0
    buffer_load_dwordx4 v[100:103], v4, s[16:19], 0 offen offset:16
    buffer_load_dwordx4 v[104:107], v4, s[16:19], 0 offen offset:32
    buffer_load_dwordx4 v[108:111], v4, s[16:19], 0 offen offset:48
    v_lshrrev_b32 v5, 3, v0
    v_add_u32 v5, s4, v5
    v_mul_u32_u24 v6, 1280, v5
    v_lshlrev_b32 v7, 1, v3
    v_add_u32 v6, v6, v7
    v_add_u32 v7, 0, v6
    buffer_load_dwordx4 v[32:35], v7, s[8:11], 0 offen
    v_add_u32 v7, -1280, v6
    buffer_load_dwordx4 v[36:39], v7, s[8:11], 0 offen
    v_add_u32 v7, -2560, v6
    buffer_load_dwordx4 v[40:43], v7, s[8:11], 0 offen
    v_add_u32 v7, -3840, v6
    buffer_load_dwordx4 v[44:47], v7, s[8:11], 0 offen
    v_add_u32 v7, 0, v6
    buffer_load_dwordx4 v[64:67], v7, s[12:15], 0 offen
    v_add_u32 v7, 40960, v6
    buffer_load_dwordx4 v[48:51], v7, s[8:11], 0 offen
    v_add_u32 v7, 39680, v6
    buffer_load_dwordx4 v[52:55], v7, s[8:11], 0 offen
    v_add_u32 v7, 38400, v6
    buffer_load_dwordx4 v[56:59], v7, s[8:11], 0 offen
    v_add_u32 v7, 37120, v6
    buffer_load_dwordx4 v[60:63], v7, s[8:11], 0 offen
    v_add_u32 v7, 40960, v6
    buffer_load_dwordx4 v[68:71], v7, s[12:15], 0 offen
    v_lshrrev_b32 v5, 3, v0
    v_sub_u32 v8, 63, v5
    v_lshlrev_b32 v8, 1, v8
    v_mul_u32_u24 v9, 1152, v2
    v_add_u32 v8, v8, v9
    s_waitcnt vmcnt(0)
    v_lshlrev_b32 v10, 16, v44
    v_and_b32 v11, 0xffff0000, v97
    v_mul_f32 v10, v10, v11
    v_cvt_pk_bf16_f32 v10, v10, v10
    v_lshlrev_b32 v10, 16, v10
    v_mov_b32 v12, v10
    v_lshlrev_b32 v10, 16, v40
    v_lshlrev_b32 v11, 16, v97
    v_mul_f32 v10, v10, v11
    v_cvt_pk_bf16_f32 v10, v10, v10
    v_lshlrev_b32 v10, 16, v10
    v_add_f32 v12, v12, v10
    v_cvt_pk_bf16_f32 v12, v12, v12
    v_lshlrev_b32 v12, 16, v12
    v_lshlrev_b32 v10, 16, v36
    v_and_b32 v11, 0xffff0000, v96
    v_mul_f32 v10, v10, v11
    v_cvt_pk_bf16_f32 v10, v10, v10
    v_lshlrev_b32 v10, 16, v10
    v_add_f32 v12, v12, v10
    v_cvt_pk_bf16_f32 v12, v12, v12
    v_lshlrev_b32 v12, 16, v12
    v_lshlrev_b32 v10, 16, v32
    v_lshlrev_b32 v11, 16, v96
    v_mul_f32 v10, v10, v11
    v_cvt_pk_bf16_f32 v10, v10, v10
    v_lshlrev_b32 v10, 16, v10
    v_add_f32 v12, v12, v10
    v_cvt_pk_bf16_f32 v12, v12, v12
    v_lshlrev_b32 v12, 16, v12
    v_lshlrev_b32 v10, 16, v64
    v_mul_f32 v12, v12, v10
    v_cvt_pk_bf16_f32 v12, v12, v12
    ds_write_b16 v8, v12 offset:0
    v_and_b32 v10, 0xffff0000, v44
    v_and_b32 v11, 0xffff0000, v99
    v_mul_f32 v10, v10, v11
    v_cvt_pk_bf16_f32 v10, v10, v10
    v_lshlrev_b32 v10, 16, v10
    v_mov_b32 v12, v10
    v_and_b32 v10, 0xffff0000, v40
    v_lshlrev_b32 v11, 16, v99
    v_mul_f32 v10, v10, v11
    v_cvt_pk_bf16_f32 v10, v10, v10
    v_lshlrev_b32 v10, 16, v10
    v_add_f32 v12, v12, v10
    v_cvt_pk_bf16_f32 v12, v12, v12
    v_lshlrev_b32 v12, 16, v12
    v_and_b32 v10, 0xffff0000, v36
    v_and_b32 v11, 0xffff0000, v98
    v_mul_f32 v10, v10, v11
    v_cvt_pk_bf16_f32 v10, v10, v10
    v_lshlrev_b32 v10, 16, v10
    v_add_f32 v12, v12, v10
    v_cvt_pk_bf16_f32 v12, v12, v12
    v_lshlrev_b32 v12, 16, v12
    v_and_b32 v10, 0xffff0000, v32
    v_lshlrev_b32 v11, 16, v98
    v_mul_f32 v10, v10, v11
    v_cvt_pk_bf16_f32 v10, v10, v10
    v_lshlrev_b32 v10, 16, v10
    v_add_f32 v12, v12, v10
    v_cvt_pk_bf16_f32 v12, v12, v12
    v_lshlrev_b32 v12, 16, v12
    v_and_b32 v10, 0xffff0000, v64
    v_mul_f32 v12, v12, v10
    v_cvt_pk_bf16_f32 v12, v12, v12
    ds_write_b16 v8, v12 offset:144
    v_lshlrev_b32 v10, 16, v45
    v_and_b32 v11, 0xffff0000, v101
    v_mul_f32 v10, v10, v11
    v_cvt_pk_bf16_f32 v10, v10, v10
    v_lshlrev_b32 v10, 16, v10
    v_mov_b32 v12, v10
    v_lshlrev_b32 v10, 16, v41
    v_lshlrev_b32 v11, 16, v101
    v_mul_f32 v10, v10, v11
    v_cvt_pk_bf16_f32 v10, v10, v10
    v_lshlrev_b32 v10, 16, v10
    v_add_f32 v12, v12, v10
    v_cvt_pk_bf16_f32 v12, v12, v12
    v_lshlrev_b32 v12, 16, v12
    v_lshlrev_b32 v10, 16, v37
    v_and_b32 v11, 0xffff0000, v100
    v_mul_f32 v10, v10, v11
    v_cvt_pk_bf16_f32 v10, v10, v10
    v_lshlrev_b32 v10, 16, v10
    v_add_f32 v12, v12, v10
    v_cvt_pk_bf16_f32 v12, v12, v12
    v_lshlrev_b32 v12, 16, v12
    v_lshlrev_b32 v10, 16, v33
    v_lshlrev_b32 v11, 16, v100
    v_mul_f32 v10, v10, v11
    v_cvt_pk_bf16_f32 v10, v10, v10
    v_lshlrev_b32 v10, 16, v10
    v_add_f32 v12, v12, v10
    v_cvt_pk_bf16_f32 v12, v12, v12
    v_lshlrev_b32 v12, 16, v12
    v_lshlrev_b32 v10, 16, v65
    v_mul_f32 v12, v12, v10
    v_cvt_pk_bf16_f32 v12, v12, v12
    ds_write_b16 v8, v12 offset:288
    v_and_b32 v10, 0xffff0000, v45
    v_and_b32 v11, 0xffff0000, v103
    v_mul_f32 v10, v10, v11
    v_cvt_pk_bf16_f32 v10, v10, v10
    v_lshlrev_b32 v10, 16, v10
    v_mov_b32 v12, v10
    v_and_b32 v10, 0xffff0000, v41
    v_lshlrev_b32 v11, 16, v103
    v_mul_f32 v10, v10, v11
    v_cvt_pk_bf16_f32 v10, v10, v10
    v_lshlrev_b32 v10, 16, v10
    v_add_f32 v12, v12, v10
    v_cvt_pk_bf16_f32 v12, v12, v12
    v_lshlrev_b32 v12, 16, v12
    v_and_b32 v10, 0xffff0000, v37
    v_and_b32 v11, 0xffff0000, v102
    v_mul_f32 v10, v10, v11
    v_cvt_pk_bf16_f32 v10, v10, v10
    v_lshlrev_b32 v10, 16, v10
    v_add_f32 v12, v12, v10
    v_cvt_pk_bf16_f32 v12, v12, v12
    v_lshlrev_b32 v12, 16, v12
    v_and_b32 v10, 0xffff0000, v33
    v_lshlrev_b32 v11, 16, v102
    v_mul_f32 v10, v10, v11
    v_cvt_pk_bf16_f32 v10, v10, v10
    v_lshlrev_b32 v10, 16, v10
    v_add_f32 v12, v12, v10
    v_cvt_pk_bf16_f32 v12, v12, v12
    v_lshlrev_b32 v12, 16, v12
    v_and_b32 v10, 0xffff0000, v65
    v_mul_f32 v12, v12, v10
    v_cvt_pk_bf16_f32 v12, v12, v12
    ds_write_b16 v8, v12 offset:432
    v_lshlrev_b32 v10, 16, v46
    v_and_b32 v11, 0xffff0000, v105
    v_mul_f32 v10, v10, v11
    v_cvt_pk_bf16_f32 v10, v10, v10
    v_lshlrev_b32 v10, 16, v10
    v_mov_b32 v12, v10
    v_lshlrev_b32 v10, 16, v42
    v_lshlrev_b32 v11, 16, v105
    v_mul_f32 v10, v10, v11
    v_cvt_pk_bf16_f32 v10, v10, v10
    v_lshlrev_b32 v10, 16, v10
    v_add_f32 v12, v12, v10
    v_cvt_pk_bf16_f32 v12, v12, v12
    v_lshlrev_b32 v12, 16, v12
    v_lshlrev_b32 v10, 16, v38
    v_and_b32 v11, 0xffff0000, v104
    v_mul_f32 v10, v10, v11
    v_cvt_pk_bf16_f32 v10, v10, v10
    v_lshlrev_b32 v10, 16, v10
    v_add_f32 v12, v12, v10
    v_cvt_pk_bf16_f32 v12, v12, v12
    v_lshlrev_b32 v12, 16, v12
    v_lshlrev_b32 v10, 16, v34
    v_lshlrev_b32 v11, 16, v104
    v_mul_f32 v10, v10, v11
    v_cvt_pk_bf16_f32 v10, v10, v10
    v_lshlrev_b32 v10, 16, v10
    v_add_f32 v12, v12, v10
    v_cvt_pk_bf16_f32 v12, v12, v12
    v_lshlrev_b32 v12, 16, v12
    v_lshlrev_b32 v10, 16, v66
    v_mul_f32 v12, v12, v10
    v_cvt_pk_bf16_f32 v12, v12, v12
    ds_write_b16 v8, v12 offset:576
    v_and_b32 v10, 0xffff0000, v46
    v_and_b32 v11, 0xffff0000, v107
    v_mul_f32 v10, v10, v11
    v_cvt_pk_bf16_f32 v10, v10, v10
    v_lshlrev_b32 v10, 16, v10
    v_mov_b32 v12, v10
    v_and_b32 v10, 0xffff0000, v42
    v_lshlrev_b32 v11, 16, v107
    v_mul_f32 v10, v10, v11
    v_cvt_pk_bf16_f32 v10, v10, v10
    v_lshlrev_b32 v10, 16, v10
    v_add_f32 v12, v12, v10
    v_cvt_pk_bf16_f32 v12, v12, v12
    v_lshlrev_b32 v12, 16, v12
    v_and_b32 v10, 0xffff0000, v38
    v_and_b32 v11, 0xffff0000, v106
    v_mul_f32 v10, v10, v11
    v_cvt_pk_bf16_f32 v10, v10, v10
    v_lshlrev_b32 v10, 16, v10
    v_add_f32 v12, v12, v10
    v_cvt_pk_bf16_f32 v12, v12, v12
    v_lshlrev_b32 v12, 16, v12
    v_and_b32 v10, 0xffff0000, v34
    v_lshlrev_b32 v11, 16, v106
    v_mul_f32 v10, v10, v11
    v_cvt_pk_bf16_f32 v10, v10, v10
    v_lshlrev_b32 v10, 16, v10
    v_add_f32 v12, v12, v10
    v_cvt_pk_bf16_f32 v12, v12, v12
    v_lshlrev_b32 v12, 16, v12
    v_and_b32 v10, 0xffff0000, v66
    v_mul_f32 v12, v12, v10
    v_cvt_pk_bf16_f32 v12, v12, v12
    ds_write_b16 v8, v12 offset:720
    v_lshlrev_b32 v10, 16, v47
    v_and_b32 v11, 0xffff0000, v109
    v_mul_f32 v10, v10, v11
    v_cvt_pk_bf16_f32 v10, v10, v10
    v_lshlrev_b32 v10, 16, v10
    v_mov_b32 v12, v10
    v_lshlrev_b32 v10, 16, v43
    v_lshlrev_b32 v11, 16, v109
    v_mul_f32 v10, v10, v11
    v_cvt_pk_bf16_f32 v10, v10, v10
    v_lshlrev_b32 v10, 16, v10
    v_add_f32 v12, v12, v10
    v_cvt_pk_bf16_f32 v12, v12, v12
    v_lshlrev_b32 v12, 16, v12
    v_lshlrev_b32 v10, 16, v39
    v_and_b32 v11, 0xffff0000, v108
    v_mul_f32 v10, v10, v11
    v_cvt_pk_bf16_f32 v10, v10, v10
    v_lshlrev_b32 v10, 16, v10
    v_add_f32 v12, v12, v10
    v_cvt_pk_bf16_f32 v12, v12, v12
    v_lshlrev_b32 v12, 16, v12
    v_lshlrev_b32 v10, 16, v35
    v_lshlrev_b32 v11, 16, v108
    v_mul_f32 v10, v10, v11
    v_cvt_pk_bf16_f32 v10, v10, v10
    v_lshlrev_b32 v10, 16, v10
    v_add_f32 v12, v12, v10
    v_cvt_pk_bf16_f32 v12, v12, v12
    v_lshlrev_b32 v12, 16, v12
    v_lshlrev_b32 v10, 16, v67
    v_mul_f32 v12, v12, v10
    v_cvt_pk_bf16_f32 v12, v12, v12
    ds_write_b16 v8, v12 offset:864
    v_and_b32 v10, 0xffff0000, v47
    v_and_b32 v11, 0xffff0000, v111
    v_mul_f32 v10, v10, v11
    v_cvt_pk_bf16_f32 v10, v10, v10
    v_lshlrev_b32 v10, 16, v10
    v_mov_b32 v12, v10
    v_and_b32 v10, 0xffff0000, v43
    v_lshlrev_b32 v11, 16, v111
    v_mul_f32 v10, v10, v11
    v_cvt_pk_bf16_f32 v10, v10, v10
    v_lshlrev_b32 v10, 16, v10
    v_add_f32 v12, v12, v10
    v_cvt_pk_bf16_f32 v12, v12, v12
    v_lshlrev_b32 v12, 16, v12
    v_and_b32 v10, 0xffff0000, v39
    v_and_b32 v11, 0xffff0000, v110
    v_mul_f32 v10, v10, v11
    v_cvt_pk_bf16_f32 v10, v10, v10
    v_lshlrev_b32 v10, 16, v10
    v_add_f32 v12, v12, v10
    v_cvt_pk_bf16_f32 v12, v12, v12
    v_lshlrev_b32 v12, 16, v12
    v_and_b32 v10, 0xffff0000, v35
    v_lshlrev_b32 v11, 16, v110
    v_mul_f32 v10, v10, v11
    v_cvt_pk_bf16_f32 v10, v10, v10
    v_lshlrev_b32 v10, 16, v10
    v_add_f32 v12, v12, v10
    v_cvt_pk_bf16_f32 v12, v12, v12
    v_lshlrev_b32 v12, 16, v12
    v_and_b32 v10, 0xffff0000, v67
    v_mul_f32 v12, v12, v10
    v_cvt_pk_bf16_f32 v12, v12, v12
    ds_write_b16 v8, v12 offset:1008
    v_subrev_u32 v13, 64, v8
    v_lshlrev_b32 v10, 16, v60
    v_and_b32 v11, 0xffff0000, v97
    v_mul_f32 v10, v10, v11
    v_cvt_pk_bf16_f32 v10, v10, v10
    v_lshlrev_b32 v10, 16, v10
    v_mov_b32 v12, v10
    v_lshlrev_b32 v10, 16, v56
    v_lshlrev_b32 v11, 16, v97
    v_mul_f32 v10, v10, v11
    v_cvt_pk_bf16_f32 v10, v10, v10
    v_lshlrev_b32 v10, 16, v10
    v_add_f32 v12, v12, v10
    v_cvt_pk_bf16_f32 v12, v12, v12
    v_lshlrev_b32 v12, 16, v12
    v_lshlrev_b32 v10, 16, v52
    v_and_b32 v11, 0xffff0000, v96
    v_mul_f32 v10, v10, v11
    v_cvt_pk_bf16_f32 v10, v10, v10
    v_lshlrev_b32 v10, 16, v10
    v_add_f32 v12, v12, v10
    v_cvt_pk_bf16_f32 v12, v12, v12
    v_lshlrev_b32 v12, 16, v12
    v_lshlrev_b32 v10, 16, v48
    v_lshlrev_b32 v11, 16, v96
    v_mul_f32 v10, v10, v11
    v_cvt_pk_bf16_f32 v10, v10, v10
    v_lshlrev_b32 v10, 16, v10
    v_add_f32 v12, v12, v10
    v_cvt_pk_bf16_f32 v12, v12, v12
    v_lshlrev_b32 v12, 16, v12
    v_lshlrev_b32 v10, 16, v68
    v_mul_f32 v12, v12, v10
    v_cvt_pk_bf16_f32 v12, v12, v12
    ds_write_b16 v13, v12 offset:0
    v_and_b32 v10, 0xffff0000, v60
    v_and_b32 v11, 0xffff0000, v99
    v_mul_f32 v10, v10, v11
    v_cvt_pk_bf16_f32 v10, v10, v10
    v_lshlrev_b32 v10, 16, v10
    v_mov_b32 v12, v10
    v_and_b32 v10, 0xffff0000, v56
    v_lshlrev_b32 v11, 16, v99
    v_mul_f32 v10, v10, v11
    v_cvt_pk_bf16_f32 v10, v10, v10
    v_lshlrev_b32 v10, 16, v10
    v_add_f32 v12, v12, v10
    v_cvt_pk_bf16_f32 v12, v12, v12
    v_lshlrev_b32 v12, 16, v12
    v_and_b32 v10, 0xffff0000, v52
    v_and_b32 v11, 0xffff0000, v98
    v_mul_f32 v10, v10, v11
    v_cvt_pk_bf16_f32 v10, v10, v10
    v_lshlrev_b32 v10, 16, v10
    v_add_f32 v12, v12, v10
    v_cvt_pk_bf16_f32 v12, v12, v12
    v_lshlrev_b32 v12, 16, v12
    v_and_b32 v10, 0xffff0000, v48
    v_lshlrev_b32 v11, 16, v98
    v_mul_f32 v10, v10, v11
    v_cvt_pk_bf16_f32 v10, v10, v10
    v_lshlrev_b32 v10, 16, v10
    v_add_f32 v12, v12, v10
    v_cvt_pk_bf16_f32 v12, v12, v12
    v_lshlrev_b32 v12, 16, v12
    v_and_b32 v10, 0xffff0000, v68
    v_mul_f32 v12, v12, v10
    v_cvt_pk_bf16_f32 v12, v12, v12
    ds_write_b16 v13, v12 offset:144
    v_lshlrev_b32 v10, 16, v61
    v_and_b32 v11, 0xffff0000, v101
    v_mul_f32 v10, v10, v11
    v_cvt_pk_bf16_f32 v10, v10, v10
    v_lshlrev_b32 v10, 16, v10
    v_mov_b32 v12, v10
    v_lshlrev_b32 v10, 16, v57
    v_lshlrev_b32 v11, 16, v101
    v_mul_f32 v10, v10, v11
    v_cvt_pk_bf16_f32 v10, v10, v10
    v_lshlrev_b32 v10, 16, v10
    v_add_f32 v12, v12, v10
    v_cvt_pk_bf16_f32 v12, v12, v12
    v_lshlrev_b32 v12, 16, v12
    v_lshlrev_b32 v10, 16, v53
    v_and_b32 v11, 0xffff0000, v100
    v_mul_f32 v10, v10, v11
    v_cvt_pk_bf16_f32 v10, v10, v10
    v_lshlrev_b32 v10, 16, v10
    v_add_f32 v12, v12, v10
    v_cvt_pk_bf16_f32 v12, v12, v12
    v_lshlrev_b32 v12, 16, v12
    v_lshlrev_b32 v10, 16, v49
    v_lshlrev_b32 v11, 16, v100
    v_mul_f32 v10, v10, v11
    v_cvt_pk_bf16_f32 v10, v10, v10
    v_lshlrev_b32 v10, 16, v10
    v_add_f32 v12, v12, v10
    v_cvt_pk_bf16_f32 v12, v12, v12
    v_lshlrev_b32 v12, 16, v12
    v_lshlrev_b32 v10, 16, v69
    v_mul_f32 v12, v12, v10
    v_cvt_pk_bf16_f32 v12, v12, v12
    ds_write_b16 v13, v12 offset:288
    v_and_b32 v10, 0xffff0000, v61
    v_and_b32 v11, 0xffff0000, v103
    v_mul_f32 v10, v10, v11
    v_cvt_pk_bf16_f32 v10, v10, v10
    v_lshlrev_b32 v10, 16, v10
    v_mov_b32 v12, v10
    v_and_b32 v10, 0xffff0000, v57
    v_lshlrev_b32 v11, 16, v103
    v_mul_f32 v10, v10, v11
    v_cvt_pk_bf16_f32 v10, v10, v10
    v_lshlrev_b32 v10, 16, v10
    v_add_f32 v12, v12, v10
    v_cvt_pk_bf16_f32 v12, v12, v12
    v_lshlrev_b32 v12, 16, v12
    v_and_b32 v10, 0xffff0000, v53
    v_and_b32 v11, 0xffff0000, v102
    v_mul_f32 v10, v10, v11
    v_cvt_pk_bf16_f32 v10, v10, v10
    v_lshlrev_b32 v10, 16, v10
    v_add_f32 v12, v12, v10
    v_cvt_pk_bf16_f32 v12, v12, v12
    v_lshlrev_b32 v12, 16, v12
    v_and_b32 v10, 0xffff0000, v49
    v_lshlrev_b32 v11, 16, v102
    v_mul_f32 v10, v10, v11
    v_cvt_pk_bf16_f32 v10, v10, v10
    v_lshlrev_b32 v10, 16, v10
    v_add_f32 v12, v12, v10
    v_cvt_pk_bf16_f32 v12, v12, v12
    v_lshlrev_b32 v12, 16, v12
    v_and_b32 v10, 0xffff0000, v69
    v_mul_f32 v12, v12, v10
    v_cvt_pk_bf16_f32 v12, v12, v12
    ds_write_b16 v13, v12 offset:432
    v_lshlrev_b32 v10, 16, v62
    v_and_b32 v11, 0xffff0000, v105
    v_mul_f32 v10, v10, v11
    v_cvt_pk_bf16_f32 v10, v10, v10
    v_lshlrev_b32 v10, 16, v10
    v_mov_b32 v12, v10
    v_lshlrev_b32 v10, 16, v58
    v_lshlrev_b32 v11, 16, v105
    v_mul_f32 v10, v10, v11
    v_cvt_pk_bf16_f32 v10, v10, v10
    v_lshlrev_b32 v10, 16, v10
    v_add_f32 v12, v12, v10
    v_cvt_pk_bf16_f32 v12, v12, v12
    v_lshlrev_b32 v12, 16, v12
    v_lshlrev_b32 v10, 16, v54
    v_and_b32 v11, 0xffff0000, v104
    v_mul_f32 v10, v10, v11
    v_cvt_pk_bf16_f32 v10, v10, v10
    v_lshlrev_b32 v10, 16, v10
    v_add_f32 v12, v12, v10
    v_cvt_pk_bf16_f32 v12, v12, v12
    v_lshlrev_b32 v12, 16, v12
    v_lshlrev_b32 v10, 16, v50
    v_lshlrev_b32 v11, 16, v104
    v_mul_f32 v10, v10, v11
    v_cvt_pk_bf16_f32 v10, v10, v10
    v_lshlrev_b32 v10, 16, v10
    v_add_f32 v12, v12, v10
    v_cvt_pk_bf16_f32 v12, v12, v12
    v_lshlrev_b32 v12, 16, v12
    v_lshlrev_b32 v10, 16, v70
    v_mul_f32 v12, v12, v10
    v_cvt_pk_bf16_f32 v12, v12, v12
    ds_write_b16 v13, v12 offset:576
    v_and_b32 v10, 0xffff0000, v62
    v_and_b32 v11, 0xffff0000, v107
    v_mul_f32 v10, v10, v11
    v_cvt_pk_bf16_f32 v10, v10, v10
    v_lshlrev_b32 v10, 16, v10
    v_mov_b32 v12, v10
    v_and_b32 v10, 0xffff0000, v58
    v_lshlrev_b32 v11, 16, v107
    v_mul_f32 v10, v10, v11
    v_cvt_pk_bf16_f32 v10, v10, v10
    v_lshlrev_b32 v10, 16, v10
    v_add_f32 v12, v12, v10
    v_cvt_pk_bf16_f32 v12, v12, v12
    v_lshlrev_b32 v12, 16, v12
    v_and_b32 v10, 0xffff0000, v54
    v_and_b32 v11, 0xffff0000, v106
    v_mul_f32 v10, v10, v11
    v_cvt_pk_bf16_f32 v10, v10, v10
    v_lshlrev_b32 v10, 16, v10
    v_add_f32 v12, v12, v10
    v_cvt_pk_bf16_f32 v12, v12, v12
    v_lshlrev_b32 v12, 16, v12
    v_and_b32 v10, 0xffff0000, v50
    v_lshlrev_b32 v11, 16, v106
    v_mul_f32 v10, v10, v11
    v_cvt_pk_bf16_f32 v10, v10, v10
    v_lshlrev_b32 v10, 16, v10
    v_add_f32 v12, v12, v10
    v_cvt_pk_bf16_f32 v12, v12, v12
    v_lshlrev_b32 v12, 16, v12
    v_and_b32 v10, 0xffff0000, v70
    v_mul_f32 v12, v12, v10
    v_cvt_pk_bf16_f32 v12, v12, v12
    ds_write_b16 v13, v12 offset:720
    v_lshlrev_b32 v10, 16, v63
    v_and_b32 v11, 0xffff0000, v109
    v_mul_f32 v10, v10, v11
    v_cvt_pk_bf16_f32 v10, v10, v10
    v_lshlrev_b32 v10, 16, v10
    v_mov_b32 v12, v10
    v_lshlrev_b32 v10, 16, v59
    v_lshlrev_b32 v11, 16, v109
    v_mul_f32 v10, v10, v11
    v_cvt_pk_bf16_f32 v10, v10, v10
    v_lshlrev_b32 v10, 16, v10
    v_add_f32 v12, v12, v10
    v_cvt_pk_bf16_f32 v12, v12, v12
    v_lshlrev_b32 v12, 16, v12
    v_lshlrev_b32 v10, 16, v55
    v_and_b32 v11, 0xffff0000, v108
    v_mul_f32 v10, v10, v11
    v_cvt_pk_bf16_f32 v10, v10, v10
    v_lshlrev_b32 v10, 16, v10
    v_add_f32 v12, v12, v10
    v_cvt_pk_bf16_f32 v12, v12, v12
    v_lshlrev_b32 v12, 16, v12
    v_lshlrev_b32 v10, 16, v51
    v_lshlrev_b32 v11, 16, v108
    v_mul_f32 v10, v10, v11
    v_cvt_pk_bf16_f32 v10, v10, v10
    v_lshlrev_b32 v10, 16, v10
    v_add_f32 v12, v12, v10
    v_cvt_pk_bf16_f32 v12, v12, v12
    v_lshlrev_b32 v12, 16, v12
    v_lshlrev_b32 v10, 16, v71
    v_mul_f32 v12, v12, v10
    v_cvt_pk_bf16_f32 v12, v12, v12
    ds_write_b16 v13, v12 offset:864
    v_and_b32 v10, 0xffff0000, v63
    v_and_b32 v11, 0xffff0000, v111
    v_mul_f32 v10, v10, v11
    v_cvt_pk_bf16_f32 v10, v10, v10
    v_lshlrev_b32 v10, 16, v10
    v_mov_b32 v12, v10
    v_and_b32 v10, 0xffff0000, v59
    v_lshlrev_b32 v11, 16, v111
    v_mul_f32 v10, v10, v11
    v_cvt_pk_bf16_f32 v10, v10, v10
    v_lshlrev_b32 v10, 16, v10
    v_add_f32 v12, v12, v10
    v_cvt_pk_bf16_f32 v12, v12, v12
    v_lshlrev_b32 v12, 16, v12
    v_and_b32 v10, 0xffff0000, v55
    v_and_b32 v11, 0xffff0000, v110
    v_mul_f32 v10, v10, v11
    v_cvt_pk_bf16_f32 v10, v10, v10
    v_lshlrev_b32 v10, 16, v10
    v_add_f32 v12, v12, v10
    v_cvt_pk_bf16_f32 v12, v12, v12
    v_lshlrev_b32 v12, 16, v12
    v_and_b32 v10, 0xffff0000, v51
    v_lshlrev_b32 v11, 16, v110
    v_mul_f32 v10, v10, v11
    v_cvt_pk_bf16_f32 v10, v10, v10
    v_lshlrev_b32 v10, 16, v10
    v_add_f32 v12, v12, v10
    v_cvt_pk_bf16_f32 v12, v12, v12
    v_lshlrev_b32 v12, 16, v12
    v_and_b32 v10, 0xffff0000, v71
    v_mul_f32 v12, v12, v10
    v_cvt_pk_bf16_f32 v12, v12, v12
    ds_write_b16 v13, v12 offset:1008
    v_lshrrev_b32 v5, 3, v0
    v_add_u32 v5, s5, v5
    v_lshlrev_b32 v5, 12, v5
    s_sub_u32 s6, 1984, s4
    s_lshl_b32 s6, s6, 1
    v_lshlrev_b32 v6, 4, v2
    v_add_u32 v5, v5, v6
    v_add_u32 v14, s6, v5
    v_add_u32 v15, 131072, v14
    s_waitcnt lgkmcnt(0)
    s_barrier
    v_lshrrev_b32 v20, 3, v0
    v_mul_u32_u24 v20, 144, v20
    v_and_b32 v21, 7, v0
    v_lshlrev_b32 v21, 4, v21
    v_add_u32 v20, v20, v21
    ds_read_b128 v[24:27], v20
    ds_read_b128 v[28:31], v20 offset:4608
    s_waitcnt lgkmcnt(1)
    buffer_store_dwordx4 v[24:27], v14, s[20:23], 0 offen
    s_waitcnt lgkmcnt(0)
    buffer_store_dwordx4 v[28:31], v15, s[20:23], 0 offen
    s_branch prep_end
prep_jobC:
    s_sub_u32 s3, s33, 448
    s_mul_i32 s4, s3, 243
    s_lshr_b32 s4, s4, 16
    s_mul_i32 s6, s4, 270
    s_sub_u32 s5, s3, s6
    s_cmp_eq_u32 s4, 2
    s_cbranch_scc1 prep_jobC_down
    s_mul_i32 s6, s5, 19
    s_lshr_b32 s6, s6, 9
    s_mul_i32 s3, s6, 27
    s_sub_u32 s7, s5, s3
    s_cmp_eq_u32 s4, 0
    s_cselect_b32 s8, s50, s52
    s_cselect_b32 s9, s51, s53
    s_mov_b32 s10, 2211840
    s_mov_b32 s11, 0x00020000
    s_add_u32 s12, s56, 5242880
    s_addc_u32 s13, s57, 0
    s_mov_b32 s14, 10485760
    s_mov_b32 s15, 0x00020000
    s_lshl_b32 s6, s6, 6
    s_lshl_b32 s7, s7, 6
    s_mov_b32 s16, 3456
    s_mov_b32 s17, 1280
    v_lshrrev_b32 v5, 3, v0
    v_add_u32 v6, s7, v5
    v_lshrrev_b32 v7, 5, v6
    v_lshlrev_b32 v7, 6, v7
    v_and_b32 v6, 31, v6
    v_add_u32 v6, v6, v7
    s_lshl_b32 s18, s4, 5
    v_add_u32 v6, s18, v6
    v_add_u32 v14, 0, v6
    v_add_u32 v6, s7, v5
    v_add_u32 v6, 32, v6
    v_lshrrev_b32 v7, 5, v6
    v_lshlrev_b32 v7, 6, v7
    v_and_b32 v6, 31, v6
    v_add_u32 v6, v6, v7
    s_lshl_b32 s18, s4, 5
    v_add_u32 v6, s18, v6
    v_add_u32 v15, 0, v6
    s_branch prep_jobC_common
prep_jobC_down:
    s_mul_i32 s6, s5, 205
    s_lshr_b32 s6, s6, 11
    s_mul_i32 s3, s6, 10
    s_sub_u32 s7, s5, s3
    s_mov_b32 s8, s54
    s_mov_b32 s9, s55
    s_mov_b32 s10, 2211840
    s_mov_b32 s11, 0x00020000
    s_add_u32 s12, s56, 9699328
    s_addc_u32 s13, s57, 0
    s_mov_b32 s14, 10485760
    s_mov_b32 s15, 0x00020000
    s_lshl_b32 s6, s6, 6
    s_lshl_b32 s7, s7, 6
    s_mov_b32 s16, 1280
    s_mov_b32 s17, 3456
    v_lshrrev_b32 v5, 3, v0
    v_add_u32 v14, s7, v5
    v_add_u32 v15, 32, v14
prep_jobC_common:
    v_and_b32 v2, 7, v0
    v_lshlrev_b32 v6, 4, v2
    s_lshl_b32 s18, s6, 1
    v_add_u32 v6, s18, v6
    v_mul_lo_u32 v14, v14, s17
    v_mul_lo_u32 v15, v15, s17
    v_add_u32 v14, v14, v6
    v_add_u32 v15, v15, v6
    v_lshrrev_b32 v5, 3, v0
    v_add_u32 v5, s6, v5
    v_mul_lo_u32 v5, v5, s16
    v_lshlrev_b32 v6, 4, v2
    s_lshl_b32 s18, s7, 1
    v_add_u32 v6, s18, v6
    v_add_u32 v5, v5, v6
    s_lshl_b32 s18, s16, 5
    buffer_load_dwordx4 v[32:35], v5, s[8:11], 0 offen
    buffer_load_dwordx4 v[36:39], v5, s[8:11], s18 offen
    v_lshrrev_b32 v8, 3, v0
    v_lshlrev_b32 v8, 1, v8
    v_mul_u32_u24 v9, 1152, v2
    v_add_u32 v8, v8, v9
    s_waitcnt vmcnt(0)
    ds_write_b16 v8, v32 offset:0
    ds_write_b16_d16_hi v8, v32 offset:144
    ds_write_b16 v8, v33 offset:288
    ds_write_b16_d16_hi v8, v33 offset:432
    ds_write_b16 v8, v34 offset:576
    ds_write_b16_d16_hi v8, v34 offset:720
    ds_write_b16 v8, v35 offset:864
    ds_write_b16_d16_hi v8, v35 offset:1008
    ds_write_b16 v8, v36 offset:64
    ds_write_b16_d16_hi v8, v36 offset:208
    ds_write_b16 v8, v37 offset:352
    ds_write_b16_d16_hi v8, v37 offset:496
    ds_write_b16 v8, v38 offset:640
    ds_write_b16_d16_hi v8, v38 offset:784
    ds_write_b16 v8, v39 offset:928
    ds_write_b16_d16_hi v8, v39 offset:1072
    s_waitcnt lgkmcnt(0)
    s_barrier
    v_lshrrev_b32 v20, 3, v0
    v_mul_u32_u24 v20, 144, v20
    v_and_b32 v21, 7, v0
    v_lshlrev_b32 v21, 4, v21
    v_add_u32 v20, v20, v21
    ds_read_b128 v[24:27], v20
    ds_read_b128 v[28:31], v20 offset:4608
    s_waitcnt lgkmcnt(1)
    buffer_store_dwordx4 v[24:27], v14, s[12:15], 0 offen
    s_waitcnt lgkmcnt(0)
    buffer_store_dwordx4 v[28:31], v15, s[12:15], 0 offen
prep_end:
    s_endpgm
.section .rodata,"a"
.p2align 6
.amdhsa_kernel prep_kernel
  .amdhsa_next_free_vgpr 112
  .amdhsa_next_free_sgpr 64
  .amdhsa_accum_offset 112
  .amdhsa_group_segment_fixed_size 0
  .amdhsa_kernarg_size 104
  .amdhsa_user_sgpr_count 2
  .amdhsa_user_sgpr_kernarg_segment_ptr 1
  .amdhsa_system_sgpr_workgroup_id_x 1
.end_amdhsa_kernel
.text

.globl mix_kernel
.p2align 8
.type mix_kernel,@function
mix_kernel:
    s_cmp_ge_u32 s2, 1080
    s_cbranch_scc1 mix_end
    s_and_b32 s6, s2, 7
    s_lshr_b32 s7, s2, 3
    s_mul_i32 s4, s7, 205
    s_lshr_b32 s4, s4, 10
    s_mul_i32 s3, s4, 5
    s_sub_u32 s5, s7, s3
    s_cmp_ge_u32 s5, 2
    s_cbranch_scc1 mix_conv
    s_lshl_b32 s4, s4, 1
    s_add_u32 s4, s4, s5
    s_lshl_b32 s4, s4, 3
    s_add_u32 s2, s4, s6
    s_branch mix_gemm
mix_conv:
    s_mul_i32 s4, s4, 3
    s_add_u32 s4, s4, s5
    s_sub_u32 s4, s4, 2
    s_lshl_b32 s4, s4, 3
    s_add_u32 s2, s4, s6
    s_branch mix_convbody
mix_end:
    s_endpgm
mix_gemm:
    s_mov_b32 s33, s2
    s_load_dwordx2 s[40:41], s[0:1], 96
    s_load_dwordx2 s[42:43], s[0:1], 0
    s_load_dwordx2 s[44:45], s[0:1], 80
    s_load_dwordx2 s[46:47], s[0:1], 40
    s_cmp_ge_u32 s33, 432
    s_cbranch_scc1 gemm1_end
    s_and_b32 s38, s33, 7
    s_lshr_b32 s39, s33, 3
    s_mul_i32 s5, s39, 128
    s_lshr_b32 s5, s5, 8
    s_mul_i32 s3, s5, 2
    s_sub_u32 s4, s39, s3
    s_mul_i32 s38, s38, 2
    s_add_u32 s4, s4, s38
    s_waitcnt lgkmcnt(0)
    s_add_u32 s8, s40, 5242880
    s_addc_u32 s9, s41, 0
    s_mov_b32 s10, 4423680
    s_mov_b32 s11, 0x00020000
    s_add_u32 s12, s40, 0
    s_addc_u32 s13, s41, 0
    s_mov_b32 s14, 2621440
    s_mov_b32 s15, 0x00020000
    s_mul_i32 s6, s5, 128
    s_mul_i32 s7, s4, 128
    v_and_b32 v1, 63, v0
    v_lshrrev_b32 v2, 6, v0
    s_nop 0
    v_readfirstlane_b32 s34, v2
    v_lshrrev_b32 v3, 3, v1
    v_and_b32 v4, 7, v1
    v_lshrrev_b32 v5, 4, v1
    v_mul_u32_u24 v6, 32, v2
    v_add_u32 v6, 0, v6
    v_add_u32 v6, v6, v3
    v_add_u32 v6, s6, v6
    v_mul_u32_u24 v6, 1280, v6
    v_add_u32 v7, 0, v5
    v_and_b32 v7, 7, v7
    v_xor_b32 v7, v7, v4
    v_lshlrev_b32 v7, 4, v7
    v_add_u32 v8, v6, v7
    v_mul_u32_u24 v6, 32, v2
    v_add_u32 v6, 8, v6
    v_add_u32 v6, v6, v3
    v_add_u32 v6, s6, v6
    v_mul_u32_u24 v6, 1280, v6
    v_add_u32 v7, 4, v5
    v_and_b32 v7, 7, v7
    v_xor_b32 v7, v7, v4
    v_lshlrev_b32 v7, 4, v7
    v_add_u32 v9, v6, v7
    v_mul_u32_u24 v6, 32, v2
    v_add_u32 v6, 16, v6
    v_add_u32 v6, v6, v3
    v_add_u32 v6, s6, v6
    v_mul_u32_u24 v6, 1280, v6
    v_add_u32 v7, 8, v5
    v_and_b32 v7, 7, v7
    v_xor_b32 v7, v7, v4
    v_lshlrev_b32 v7, 4, v7
    v_add_u32 v10, v6, v7
    v_mul_u32_u24 v6, 32, v2
    v_add_u32 v6, 24, v6
    v_add_u32 v6, v6, v3
    v_add_u32 v6, s6, v6
    v_mul_u32_u24 v6, 1280, v6
    v_add_u32 v7, 12, v5
    v_and_b32 v7, 7, v7
    v_xor_b32 v7, v7, v4
    v_lshlrev_b32 v7, 4, v7
    v_add_u32 v11, v6, v7
    v_mul_u32_u24 v6, 32, v2
    v_add_u32 v6, 0, v6
    v_add_u32 v6, v6, v3
    v_add_u32 v6, s7, v6
    v_mul_u32_u24 v6, 1280, v6
    v_add_u32 v7, 0, v5
    v_and_b32 v7, 7, v7
    v_xor_b32 v7, v7, v4
    v_lshlrev_b32 v7, 4, v7
    v_add_u32 v12, v6, v7
    v_mul_u32_u24 v6, 32, v2
    v_add_u32 v6, 8, v6
    v_add_u32 v6, v6, v3
    v_add_u32 v6, s7, v6
    v_mul_u32_u24 v6, 1280, v6
    v_add_u32 v7, 4, v5
    v_and_b32 v7, 7, v7
    v_xor_b32 v7, v7, v4
    v_lshlrev_b32 v7, 4, v7
    v_add_u32 v13, v6, v7
    v_mul_u32_u24 v6, 32, v2
    v_add_u32 v6, 16, v6
    v_add_u32 v6, v6, v3
    v_add_u32 v6, s7, v6
    v_mul_u32_u24 v6, 1280, v6
    v_add_u32 v7, 8, v5
    v_and_b32 v7, 7, v7
    v_xor_b32 v7, v7, v4
    v_lshlrev_b32 v7, 4, v7
    v_add_u32 v14, v6, v7
    v_mul_u32_u24 v6, 32, v2
    v_add_u32 v6, 24, v6
    v_add_u32 v6, v6, v3
    v_add_u32 v6, s7, v6
    v_mul_u32_u24 v6, 1280, v6
    v_add_u32 v7, 12, v5
    v_and_b32 v7, 7, v7
    v_xor_b32 v7, v7, v4
    v_lshlrev_b32 v7, 4, v7
    v_add_u32 v15, v6, v7
    s_mul_i32 s35, s34, 4096
    s_mul_i32 s36, s34, 4096
    s_add_u32 s36, s36, 16384
    v_and_b32 v3, 31, v1
    v_lshrrev_b32 v4, 5, v1
    v_lshrrev_b32 v5, 1, v3
    v_and_b32 v5, 7, v5
    v_lshrrev_b32 v6, 1, v2
    v_and_b32 v7, 1, v2
    v_add_u32 v24, 0, v4
    v_xor_b32 v24, v24, v5
    v_lshlrev_b32 v24, 4, v24
    v_lshlrev_b32 v25, 7, v3
    v_add_u32 v24, v24, v25
    v_mul_u32_u24 v25, 8192, v6
    v_add_u32 v64, v24, v25
    v_mul_u32_u24 v25, 8192, v7
    v_add_u32 v25, 16384, v25
    v_add_u32 v68, v24, v25
    v_add_u32 v24, 2, v4
    v_xor_b32 v24, v24, v5
    v_lshlrev_b32 v24, 4, v24
    v_lshlrev_b32 v25, 7, v3
    v_add_u32 v24, v24, v25
    v_mul_u32_u24 v25, 8192, v6
    v_add_u32 v65, v24, v25
    v_mul_u32_u24 v25, 8192, v7
    v_add_u32 v25, 16384, v25
    v_add_u32 v69, v24, v25
    v_add_u32 v24, 4, v4
    v_xor_b32 v24, v24, v5
    v_lshlrev_b32 v24, 4, v24
    v_lshlrev_b32 v25, 7, v3
    v_add_u32 v24, v24, v25
    v_mul_u32_u24 v25, 8192, v6
    v_add_u32 v66, v24, v25
    v_mul_u32_u24 v25, 8192, v7
    v_add_u32 v25, 16384, v25
    v_add_u32 v70, v24, v25
    v_add_u32 v24, 6, v4
    v_xor_b32 v24, v24, v5
    v_lshlrev_b32 v24, 4, v24
    v_lshlrev_b32 v25, 7, v3
    v_add_u32 v24, v24, v25
    v_mul_u32_u24 v25, 8192, v6
    v_add_u32 v67, v24, v25
    v_mul_u32_u24 v25, 8192, v7
    v_add_u32 v25, 16384, v25
    v_add_u32 v71, v24, v25
    v_mov_b32 v72, 0
    v_mov_b32 v73, 0
    v_mov_b32 v74, 0
    v_mov_b32 v75, 0
    v_mov_b32 v76, 0
    v_mov_b32 v77, 0
    v_mov_b32 v78, 0
    v_mov_b32 v79, 0
    v_mov_b32 v80, 0
    v_mov_b32 v81, 0
    v_mov_b32 v82, 0
    v_mov_b32 v83, 0
    v_mov_b32 v84, 0
    v_mov_b32 v85, 0
    v_mov_b32 v86, 0
    v_mov_b32 v87, 0
    v_mov_b32 v88, 0
    v_mov_b32 v89, 0
    v_mov_b32 v90, 0
    v_mov_b32 v91, 0
    v_mov_b32 v92, 0
    v_mov_b32 v93, 0
    v_mov_b32 v94, 0
    v_mov_b32 v95, 0
    v_mov_b32 v96, 0
    v_mov_b32 v97, 0
    v_mov_b32 v98, 0
    v_mov_b32 v99, 0
    v_mov_b32 v100, 0
    v_mov_b32 v101, 0
    v_mov_b32 v102, 0
    v_mov_b32 v103, 0
    v_mov_b32 v104, 0
    v_mov_b32 v105, 0
    v_mov_b32 v106, 0
    v_mov_b32 v107, 0
    v_mov_b32 v108, 0
    v_mov_b32 v109, 0
    v_mov_b32 v110, 0
    v_mov_b32 v111, 0
    v_mov_b32 v112, 0
    v_mov_b32 v113, 0
    v_mov_b32 v114, 0
    v_mov_b32 v115, 0
    v_mov_b32 v116, 0
    v_mov_b32 v117, 0
    v_mov_b32 v118, 0
    v_mov_b32 v119, 0
    v_mov_b32 v120, 0
    v_mov_b32 v121, 0
    v_mov_b32 v122, 0
    v_mov_b32 v123, 0
    v_mov_b32 v124, 0
    v_mov_b32 v125, 0
    v_mov_b32 v126, 0
    v_mov_b32 v127, 0
    v_mov_b32 v128, 0
    v_mov_b32 v129, 0
    v_mov_b32 v130, 0
    v_mov_b32 v131, 0
    v_mov_b32 v132, 0
    v_mov_b32 v133, 0
    v_mov_b32 v134, 0
    v_mov_b32 v135, 0
    v_add_u32 v136, 0xc000, v64
    v_add_u32 v137, 0xc000, v65
    v_add_u32 v138, 0xc000, v66
    v_add_u32 v139, 0xc000, v67
    v_add_u32 v140, 0xc000, v68
    v_add_u32 v141, 0xc000, v69
    v_add_u32 v142, 0xc000, v70
    v_add_u32 v143, 0xc000, v71
    s_mov_b32 s37, 0
    s_add_u32 m0, s35, 0
    s_nop 0
    buffer_load_dwordx4 v8, s[8:11], s37 offen lds
    s_add_u32 m0, s35, 1024
    s_nop 0
    buffer_load_dwordx4 v9, s[8:11], s37 offen lds
    s_add_u32 m0, s35, 2048
    s_nop 0
    buffer_load_dwordx4 v10, s[8:11], s37 offen lds
    s_add_u32 m0, s35, 3072
    s_nop 0
    buffer_load_dwordx4 v11, s[8:11], s37 offen lds
    s_add_u32 m0, s36, 0
    s_nop 0
    buffer_load_dwordx4 v12, s[12:15], s37 offen lds
    s_add_u32 m0, s36, 1024
    s_nop 0
    buffer_load_dwordx4 v13, s[12:15], s37 offen lds
    s_add_u32 m0, s36, 2048
    s_nop 0
    buffer_load_dwordx4 v14, s[12:15], s37 offen lds
    s_add_u32 m0, s36, 3072
    s_nop 0
    buffer_load_dwordx4 v15, s[12:15], s37 offen lds
    s_waitcnt vmcnt(0)
    s_barrier
    s_mov_b32 s37, 128
    s_add_u32 m0, s35, 32768
    s_nop 0
    buffer_load_dwordx4 v8, s[8:11], s37 offen lds
    s_add_u32 m0, s35, 33792
    s_nop 0
    buffer_load_dwordx4 v9, s[8:11], s37 offen lds
    s_add_u32 m0, s35, 34816
    s_nop 0
    buffer_load_dwordx4 v10, s[8:11], s37 offen lds
    s_add_u32 m0, s35, 35840
    s_nop 0
    buffer_load_dwordx4 v11, s[8:11], s37 offen lds
    s_add_u32 m0, s36, 32768
    s_nop 0
    buffer_load_dwordx4 v12, s[12:15], s37 offen lds
    s_add_u32 m0, s36, 33792
    s_nop 0
    buffer_load_dwordx4 v13, s[12:15], s37 offen lds
    s_add_u32 m0, s36, 34816
    s_nop 0
    buffer_load_dwordx4 v14, s[12:15], s37 offen lds
    s_add_u32 m0, s36, 35840
    s_nop 0
    buffer_load_dwordx4 v15, s[12:15], s37 offen lds
    ds_read_b128 v[32:35], v64 offset:0
    ds_read_b128 v[36:39], v64 offset:4096
    ds_read_b128 v[40:43], v68 offset:0
    ds_read_b128 v[44:47], v68 offset:4096
    ds_read_b128 v[48:51], v65 offset:0
    ds_read_b128 v[52:55], v65 offset:4096
    ds_read_b128 v[56:59], v69 offset:0
    ds_read_b128 v[60:63], v69 offset:4096
    s_waitcnt lgkmcnt(4)
    v_mfma_f32_32x32x16_bf16 v[72:87], v[32:35], v[40:43], v[72:87]
    v_mfma_f32_32x32x16_bf16 v[88:103], v[32:35], v[44:47], v[88:103]
    v_mfma_f32_32x32x16_bf16 v[104:119], v[36:39], v[40:43], v[104:119]
    v_mfma_f32_32x32x16_bf16 v[120:135], v[36:39], v[44:47], v[120:135]
    ds_read_b128 v[32:35], v66 offset:0
    ds_read_b128 v[36:39], v66 offset:4096
    ds_read_b128 v[40:43], v70 offset:0
    ds_read_b128 v[44:47], v70 offset:4096
    s_waitcnt lgkmcnt(4)
    v_mfma_f32_32x32x16_bf16 v[72:87], v[48:51], v[56:59], v[72:87]
    v_mfma_f32_32x32x16_bf16 v[88:103], v[48:51], v[60:63], v[88:103]
    v_mfma_f32_32x32x16_bf16 v[104:119], v[52:55], v[56:59], v[104:119]
    v_mfma_f32_32x32x16_bf16 v[120:135], v[52:55], v[60:63], v[120:135]
    ds_read_b128 v[48:51], v67 offset:0
    ds_read_b128 v[52:55], v67 offset:4096
    ds_read_b128 v[56:59], v71 offset:0
    ds_read_b128 v[60:63], v71 offset:4096
    s_waitcnt lgkmcnt(4)
    v_mfma_f32_32x32x16_bf16 v[72:87], v[32:35], v[40:43], v[72:87]
    v_mfma_f32_32x32x16_bf16 v[88:103], v[32:35], v[44:47], v[88:103]
    v_mfma_f32_32x32x16_bf16 v[104:119], v[36:39], v[40:43], v[104:119]
    v_mfma_f32_32x32x16_bf16 v[120:135], v[36:39], v[44:47], v[120:135]
    s_waitcnt lgkmcnt(0)
    v_mfma_f32_32x32x16_bf16 v[72:87], v[48:51], v[56:59], v[72:87]
    v_mfma_f32_32x32x16_bf16 v[88:103], v[48:51], v[60:63], v[88:103]
    v_mfma_f32_32x32x16_bf16 v[104:119], v[52:55], v[56:59], v[104:119]
    v_mfma_f32_32x32x16_bf16 v[120:135], v[52:55], v[60:63], v[120:135]
    s_waitcnt vmcnt(0)
    s_barrier
    s_mov_b32 s37, 256
    s_add_u32 m0, s35, 0
    s_nop 0
    buffer_load_dwordx4 v8, s[8:11], s37 offen lds
    s_add_u32 m0, s35, 1024
    s_nop 0
    buffer_load_dwordx4 v9, s[8:11], s37 offen lds
    s_add_u32 m0, s35, 2048
    s_nop 0
    buffer_load_dwordx4 v10, s[8:11], s37 offen lds
    s_add_u32 m0, s35, 3072
    s_nop 0
    buffer_load_dwordx4 v11, s[8:11], s37 offen lds
    s_add_u32 m0, s36, 0
    s_nop 0
    buffer_load_dwordx4 v12, s[12:15], s37 offen lds
    s_add_u32 m0, s36, 1024
    s_nop 0
    buffer_load_dwordx4 v13, s[12:15], s37 offen lds
    s_add_u32 m0, s36, 2048
    s_nop 0
    buffer_load_dwordx4 v14, s[12:15], s37 offen lds
    s_add_u32 m0, s36, 3072
    s_nop 0
    buffer_load_dwordx4 v15, s[12:15], s37 offen lds
    ds_read_b128 v[32:35], v64 offset:32768
    ds_read_b128 v[36:39], v64 offset:36864
    ds_read_b128 v[40:43], v68 offset:32768
    ds_read_b128 v[44:47], v68 offset:36864
    ds_read_b128 v[48:51], v65 offset:32768
    ds_read_b128 v[52:55], v65 offset:36864
    ds_read_b128 v[56:59], v69 offset:32768
    ds_read_b128 v[60:63], v69 offset:36864
    s_waitcnt lgkmcnt(4)
    v_mfma_f32_32x32x16_bf16 v[72:87], v[32:35], v[40:43], v[72:87]
    v_mfma_f32_32x32x16_bf16 v[88:103], v[32:35], v[44:47], v[88:103]
    v_mfma_f32_32x32x16_bf16 v[104:119], v[36:39], v[40:43], v[104:119]
    v_mfma_f32_32x32x16_bf16 v[120:135], v[36:39], v[44:47], v[120:135]
    ds_read_b128 v[32:35], v66 offset:32768
    ds_read_b128 v[36:39], v66 offset:36864
    ds_read_b128 v[40:43], v70 offset:32768
    ds_read_b128 v[44:47], v70 offset:36864
    s_waitcnt lgkmcnt(4)
    v_mfma_f32_32x32x16_bf16 v[72:87], v[48:51], v[56:59], v[72:87]
    v_mfma_f32_32x32x16_bf16 v[88:103], v[48:51], v[60:63], v[88:103]
    v_mfma_f32_32x32x16_bf16 v[104:119], v[52:55], v[56:59], v[104:119]
    v_mfma_f32_32x32x16_bf16 v[120:135], v[52:55], v[60:63], v[120:135]
    ds_read_b128 v[48:51], v67 offset:32768
    ds_read_b128 v[52:55], v67 offset:36864
    ds_read_b128 v[56:59], v71 offset:32768
    ds_read_b128 v[60:63], v71 offset:36864
    s_waitcnt lgkmcnt(4)
    v_mfma_f32_32x32x16_bf16 v[72:87], v[32:35], v[40:43], v[72:87]
    v_mfma_f32_32x32x16_bf16 v[88:103], v[32:35], v[44:47], v[88:103]
    v_mfma_f32_32x32x16_bf16 v[104:119], v[36:39], v[40:43], v[104:119]
    v_mfma_f32_32x32x16_bf16 v[120:135], v[36:39], v[44:47], v[120:135]
    s_waitcnt lgkmcnt(0)
    v_mfma_f32_32x32x16_bf16 v[72:87], v[48:51], v[56:59], v[72:87]
    v_mfma_f32_32x32x16_bf16 v[88:103], v[48:51], v[60:63], v[88:103]
    v_mfma_f32_32x32x16_bf16 v[104:119], v[52:55], v[56:59], v[104:119]
    v_mfma_f32_32x32x16_bf16 v[120:135], v[52:55], v[60:63], v[120:135]
    s_waitcnt vmcnt(0)
    s_barrier
    s_mov_b32 s37, 384
    s_add_u32 m0, s35, 32768
    s_nop 0
    buffer_load_dwordx4 v8, s[8:11], s37 offen lds
    s_add_u32 m0, s35, 33792
    s_nop 0
    buffer_load_dwordx4 v9, s[8:11], s37 offen lds
    s_add_u32 m0, s35, 34816
    s_nop 0
    buffer_load_dwordx4 v10, s[8:11], s37 offen lds
    s_add_u32 m0, s35, 35840
    s_nop 0
    buffer_load_dwordx4 v11, s[8:11], s37 offen lds
    s_add_u32 m0, s36, 32768
    s_nop 0
    buffer_load_dwordx4 v12, s[12:15], s37 offen lds
    s_add_u32 m0, s36, 33792
    s_nop 0
    buffer_load_dwordx4 v13, s[12:15], s37 offen lds
    s_add_u32 m0, s36, 34816
    s_nop 0
    buffer_load_dwordx4 v14, s[12:15], s37 offen lds
    s_add_u32 m0, s36, 35840
    s_nop 0
    buffer_load_dwordx4 v15, s[12:15], s37 offen lds
    ds_read_b128 v[32:35], v64 offset:0
    ds_read_b128 v[36:39], v64 offset:4096
    ds_read_b128 v[40:43], v68 offset:0
    ds_read_b128 v[44:47], v68 offset:4096
    ds_read_b128 v[48:51], v65 offset:0
    ds_read_b128 v[52:55], v65 offset:4096
    ds_read_b128 v[56:59], v69 offset:0
    ds_read_b128 v[60:63], v69 offset:4096
    s_waitcnt lgkmcnt(4)
    v_mfma_f32_32x32x16_bf16 v[72:87], v[32:35], v[40:43], v[72:87]
    v_mfma_f32_32x32x16_bf16 v[88:103], v[32:35], v[44:47], v[88:103]
    v_mfma_f32_32x32x16_bf16 v[104:119], v[36:39], v[40:43], v[104:119]
    v_mfma_f32_32x32x16_bf16 v[120:135], v[36:39], v[44:47], v[120:135]
    ds_read_b128 v[32:35], v66 offset:0
    ds_read_b128 v[36:39], v66 offset:4096
    ds_read_b128 v[40:43], v70 offset:0
    ds_read_b128 v[44:47], v70 offset:4096
    s_waitcnt lgkmcnt(4)
    v_mfma_f32_32x32x16_bf16 v[72:87], v[48:51], v[56:59], v[72:87]
    v_mfma_f32_32x32x16_bf16 v[88:103], v[48:51], v[60:63], v[88:103]
    v_mfma_f32_32x32x16_bf16 v[104:119], v[52:55], v[56:59], v[104:119]
    v_mfma_f32_32x32x16_bf16 v[120:135], v[52:55], v[60:63], v[120:135]
    ds_read_b128 v[48:51], v67 offset:0
    ds_read_b128 v[52:55], v67 offset:4096
    ds_read_b128 v[56:59], v71 offset:0
    ds_read_b128 v[60:63], v71 offset:4096
    s_waitcnt lgkmcnt(4)
    v_mfma_f32_32x32x16_bf16 v[72:87], v[32:35], v[40:43], v[72:87]
    v_mfma_f32_32x32x16_bf16 v[88:103], v[32:35], v[44:47], v[88:103]
    v_mfma_f32_32x32x16_bf16 v[104:119], v[36:39], v[40:43], v[104:119]
    v_mfma_f32_32x32x16_bf16 v[120:135], v[36:39], v[44:47], v[120:135]
    s_waitcnt lgkmcnt(0)
    v_mfma_f32_32x32x16_bf16 v[72:87], v[48:51], v[56:59], v[72:87]
    v_mfma_f32_32x32x16_bf16 v[88:103], v[48:51], v[60:63], v[88:103]
    v_mfma_f32_32x32x16_bf16 v[104:119], v[52:55], v[56:59], v[104:119]
    v_mfma_f32_32x32x16_bf16 v[120:135], v[52:55], v[60:63], v[120:135]
    s_waitcnt vmcnt(0)
    s_barrier
    s_mov_b32 s37, 512
    s_add_u32 m0, s35, 0
    s_nop 0
    buffer_load_dwordx4 v8, s[8:11], s37 offen lds
    s_add_u32 m0, s35, 1024
    s_nop 0
    buffer_load_dwordx4 v9, s[8:11], s37 offen lds
    s_add_u32 m0, s35, 2048
    s_nop 0
    buffer_load_dwordx4 v10, s[8:11], s37 offen lds
    s_add_u32 m0, s35, 3072
    s_nop 0
    buffer_load_dwordx4 v11, s[8:11], s37 offen lds
    s_add_u32 m0, s36, 0
    s_nop 0
    buffer_load_dwordx4 v12, s[12:15], s37 offen lds
    s_add_u32 m0, s36, 1024
    s_nop 0
    buffer_load_dwordx4 v13, s[12:15], s37 offen lds
    s_add_u32 m0, s36, 2048
    s_nop 0
    buffer_load_dwordx4 v14, s[12:15], s37 offen lds
    s_add_u32 m0, s36, 3072
    s_nop 0
    buffer_load_dwordx4 v15, s[12:15], s37 offen lds
    ds_read_b128 v[32:35], v64 offset:32768
    ds_read_b128 v[36:39], v64 offset:36864
    ds_read_b128 v[40:43], v68 offset:32768
    ds_read_b128 v[44:47], v68 offset:36864
    ds_read_b128 v[48:51], v65 offset:32768
    ds_read_b128 v[52:55], v65 offset:36864
    ds_read_b128 v[56:59], v69 offset:32768
    ds_read_b128 v[60:63], v69 offset:36864
    s_waitcnt lgkmcnt(4)
    v_mfma_f32_32x32x16_bf16 v[72:87], v[32:35], v[40:43], v[72:87]
    v_mfma_f32_32x32x16_bf16 v[88:103], v[32:35], v[44:47], v[88:103]
    v_mfma_f32_32x32x16_bf16 v[104:119], v[36:39], v[40:43], v[104:119]
    v_mfma_f32_32x32x16_bf16 v[120:135], v[36:39], v[44:47], v[120:135]
    ds_read_b128 v[32:35], v66 offset:32768
    ds_read_b128 v[36:39], v66 offset:36864
    ds_read_b128 v[40:43], v70 offset:32768
    ds_read_b128 v[44:47], v70 offset:36864
    s_waitcnt lgkmcnt(4)
    v_mfma_f32_32x32x16_bf16 v[72:87], v[48:51], v[56:59], v[72:87]
    v_mfma_f32_32x32x16_bf16 v[88:103], v[48:51], v[60:63], v[88:103]
    v_mfma_f32_32x32x16_bf16 v[104:119], v[52:55], v[56:59], v[104:119]
    v_mfma_f32_32x32x16_bf16 v[120:135], v[52:55], v[60:63], v[120:135]
    ds_read_b128 v[48:51], v67 offset:32768
    ds_read_b128 v[52:55], v67 offset:36864
    ds_read_b128 v[56:59], v71 offset:32768
    ds_read_b128 v[60:63], v71 offset:36864
    s_waitcnt lgkmcnt(4)
    v_mfma_f32_32x32x16_bf16 v[72:87], v[32:35], v[40:43], v[72:87]
    v_mfma_f32_32x32x16_bf16 v[88:103], v[32:35], v[44:47], v[88:103]
    v_mfma_f32_32x32x16_bf16 v[104:119], v[36:39], v[40:43], v[104:119]
    v_mfma_f32_32x32x16_bf16 v[120:135], v[36:39], v[44:47], v[120:135]
    s_waitcnt lgkmcnt(0)
    v_mfma_f32_32x32x16_bf16 v[72:87], v[48:51], v[56:59], v[72:87]
    v_mfma_f32_32x32x16_bf16 v[88:103], v[48:51], v[60:63], v[88:103]
    v_mfma_f32_32x32x16_bf16 v[104:119], v[52:55], v[56:59], v[104:119]
    v_mfma_f32_32x32x16_bf16 v[120:135], v[52:55], v[60:63], v[120:135]
    s_waitcnt vmcnt(0)
    s_barrier
    s_mov_b32 s37, 640
    s_add_u32 m0, s35, 32768
    s_nop 0
    buffer_load_dwordx4 v8, s[8:11], s37 offen lds
    s_add_u32 m0, s35, 33792
    s_nop 0
    buffer_load_dwordx4 v9, s[8:11], s37 offen lds
    s_add_u32 m0, s35, 34816
    s_nop 0
    buffer_load_dwordx4 v10, s[8:11], s37 offen lds
    s_add_u32 m0, s35, 35840
    s_nop 0
    buffer_load_dwordx4 v11, s[8:11], s37 offen lds
    s_add_u32 m0, s36, 32768
    s_nop 0
    buffer_load_dwordx4 v12, s[12:15], s37 offen lds
    s_add_u32 m0, s36, 33792
    s_nop 0
    buffer_load_dwordx4 v13, s[12:15], s37 offen lds
    s_add_u32 m0, s36, 34816
    s_nop 0
    buffer_load_dwordx4 v14, s[12:15], s37 offen lds
    s_add_u32 m0, s36, 35840
    s_nop 0
    buffer_load_dwordx4 v15, s[12:15], s37 offen lds
    ds_read_b128 v[32:35], v64 offset:0
    ds_read_b128 v[36:39], v64 offset:4096
    ds_read_b128 v[40:43], v68 offset:0
    ds_read_b128 v[44:47], v68 offset:4096
    ds_read_b128 v[48:51], v65 offset:0
    ds_read_b128 v[52:55], v65 offset:4096
    ds_read_b128 v[56:59], v69 offset:0
    ds_read_b128 v[60:63], v69 offset:4096
    s_waitcnt lgkmcnt(4)
    v_mfma_f32_32x32x16_bf16 v[72:87], v[32:35], v[40:43], v[72:87]
    v_mfma_f32_32x32x16_bf16 v[88:103], v[32:35], v[44:47], v[88:103]
    v_mfma_f32_32x32x16_bf16 v[104:119], v[36:39], v[40:43], v[104:119]
    v_mfma_f32_32x32x16_bf16 v[120:135], v[36:39], v[44:47], v[120:135]
    ds_read_b128 v[32:35], v66 offset:0
    ds_read_b128 v[36:39], v66 offset:4096
    ds_read_b128 v[40:43], v70 offset:0
    ds_read_b128 v[44:47], v70 offset:4096
    s_waitcnt lgkmcnt(4)
    v_mfma_f32_32x32x16_bf16 v[72:87], v[48:51], v[56:59], v[72:87]
    v_mfma_f32_32x32x16_bf16 v[88:103], v[48:51], v[60:63], v[88:103]
    v_mfma_f32_32x32x16_bf16 v[104:119], v[52:55], v[56:59], v[104:119]
    v_mfma_f32_32x32x16_bf16 v[120:135], v[52:55], v[60:63], v[120:135]
    ds_read_b128 v[48:51], v67 offset:0
    ds_read_b128 v[52:55], v67 offset:4096
    ds_read_b128 v[56:59], v71 offset:0
    ds_read_b128 v[60:63], v71 offset:4096
    s_waitcnt lgkmcnt(4)
    v_mfma_f32_32x32x16_bf16 v[72:87], v[32:35], v[40:43], v[72:87]
    v_mfma_f32_32x32x16_bf16 v[88:103], v[32:35], v[44:47], v[88:103]
    v_mfma_f32_32x32x16_bf16 v[104:119], v[36:39], v[40:43], v[104:119]
    v_mfma_f32_32x32x16_bf16 v[120:135], v[36:39], v[44:47], v[120:135]
    s_waitcnt lgkmcnt(0)
    v_mfma_f32_32x32x16_bf16 v[72:87], v[48:51], v[56:59], v[72:87]
    v_mfma_f32_32x32x16_bf16 v[88:103], v[48:51], v[60:63], v[88:103]
    v_mfma_f32_32x32x16_bf16 v[104:119], v[52:55], v[56:59], v[104:119]
    v_mfma_f32_32x32x16_bf16 v[120:135], v[52:55], v[60:63], v[120:135]
    s_waitcnt vmcnt(0)
    s_barrier
    s_mov_b32 s37, 768
    s_add_u32 m0, s35, 0
    s_nop 0
    buffer_load_dwordx4 v8, s[8:11], s37 offen lds
    s_add_u32 m0, s35, 1024
    s_nop 0
    buffer_load_dwordx4 v9, s[8:11], s37 offen lds
    s_add_u32 m0, s35, 2048
    s_nop 0
    buffer_load_dwordx4 v10, s[8:11], s37 offen lds
    s_add_u32 m0, s35, 3072
    s_nop 0
    buffer_load_dwordx4 v11, s[8:11], s37 offen lds
    s_add_u32 m0, s36, 0
    s_nop 0
    buffer_load_dwordx4 v12, s[12:15], s37 offen lds
    s_add_u32 m0, s36, 1024
    s_nop 0
    buffer_load_dwordx4 v13, s[12:15], s37 offen lds
    s_add_u32 m0, s36, 2048
    s_nop 0
    buffer_load_dwordx4 v14, s[12:15], s37 offen lds
    s_add_u32 m0, s36, 3072
    s_nop 0
    buffer_load_dwordx4 v15, s[12:15], s37 offen lds
    ds_read_b128 v[32:35], v64 offset:32768
    ds_read_b128 v[36:39], v64 offset:36864
    ds_read_b128 v[40:43], v68 offset:32768
    ds_read_b128 v[44:47], v68 offset:36864
    ds_read_b128 v[48:51], v65 offset:32768
    ds_read_b128 v[52:55], v65 offset:36864
    ds_read_b128 v[56:59], v69 offset:32768
    ds_read_b128 v[60:63], v69 offset:36864
    s_waitcnt lgkmcnt(4)
    v_mfma_f32_32x32x16_bf16 v[72:87], v[32:35], v[40:43], v[72:87]
    v_mfma_f32_32x32x16_bf16 v[88:103], v[32:35], v[44:47], v[88:103]
    v_mfma_f32_32x32x16_bf16 v[104:119], v[36:39], v[40:43], v[104:119]
    v_mfma_f32_32x32x16_bf16 v[120:135], v[36:39], v[44:47], v[120:135]
    ds_read_b128 v[32:35], v66 offset:32768
    ds_read_b128 v[36:39], v66 offset:36864
    ds_read_b128 v[40:43], v70 offset:32768
    ds_read_b128 v[44:47], v70 offset:36864
    s_waitcnt lgkmcnt(4)
    v_mfma_f32_32x32x16_bf16 v[72:87], v[48:51], v[56:59], v[72:87]
    v_mfma_f32_32x32x16_bf16 v[88:103], v[48:51], v[60:63], v[88:103]
    v_mfma_f32_32x32x16_bf16 v[104:119], v[52:55], v[56:59], v[104:119]
    v_mfma_f32_32x32x16_bf16 v[120:135], v[52:55], v[60:63], v[120:135]
    ds_read_b128 v[48:51], v67 offset:32768
    ds_read_b128 v[52:55], v67 offset:36864
    ds_read_b128 v[56:59], v71 offset:32768
    ds_read_b128 v[60:63], v71 offset:36864
    s_waitcnt lgkmcnt(4)
    v_mfma_f32_32x32x16_bf16 v[72:87], v[32:35], v[40:43], v[72:87]
    v_mfma_f32_32x32x16_bf16 v[88:103], v[32:35], v[44:47], v[88:103]
    v_mfma_f32_32x32x16_bf16 v[104:119], v[36:39], v[40:43], v[104:119]
    v_mfma_f32_32x32x16_bf16 v[120:135], v[36:39], v[44:47], v[120:135]
    s_waitcnt lgkmcnt(0)
    v_mfma_f32_32x32x16_bf16 v[72:87], v[48:51], v[56:59], v[72:87]
    v_mfma_f32_32x32x16_bf16 v[88:103], v[48:51], v[60:63], v[88:103]
    v_mfma_f32_32x32x16_bf16 v[104:119], v[52:55], v[56:59], v[104:119]
    v_mfma_f32_32x32x16_bf16 v[120:135], v[52:55], v[60:63], v[120:135]
    s_waitcnt vmcnt(0)
    s_barrier
    s_mov_b32 s37, 896
    s_add_u32 m0, s35, 32768
    s_nop 0
    buffer_load_dwordx4 v8, s[8:11], s37 offen lds
    s_add_u32 m0, s35, 33792
    s_nop 0
    buffer_load_dwordx4 v9, s[8:11], s37 offen lds
    s_add_u32 m0, s35, 34816
    s_nop 0
    buffer_load_dwordx4 v10, s[8:11], s37 offen lds
    s_add_u32 m0, s35, 35840
    s_nop 0
    buffer_load_dwordx4 v11, s[8:11], s37 offen lds
    s_add_u32 m0, s36, 32768
    s_nop 0
    buffer_load_dwordx4 v12, s[12:15], s37 offen lds
    s_add_u32 m0, s36, 33792
    s_nop 0
    buffer_load_dwordx4 v13, s[12:15], s37 offen lds
    s_add_u32 m0, s36, 34816
    s_nop 0
    buffer_load_dwordx4 v14, s[12:15], s37 offen lds
    s_add_u32 m0, s36, 35840
    s_nop 0
    buffer_load_dwordx4 v15, s[12:15], s37 offen lds
    ds_read_b128 v[32:35], v64 offset:0
    ds_read_b128 v[36:39], v64 offset:4096
    ds_read_b128 v[40:43], v68 offset:0
    ds_read_b128 v[44:47], v68 offset:4096
    ds_read_b128 v[48:51], v65 offset:0
    ds_read_b128 v[52:55], v65 offset:4096
    ds_read_b128 v[56:59], v69 offset:0
    ds_read_b128 v[60:63], v69 offset:4096
    s_waitcnt lgkmcnt(4)
    v_mfma_f32_32x32x16_bf16 v[72:87], v[32:35], v[40:43], v[72:87]
    v_mfma_f32_32x32x16_bf16 v[88:103], v[32:35], v[44:47], v[88:103]
    v_mfma_f32_32x32x16_bf16 v[104:119], v[36:39], v[40:43], v[104:119]
    v_mfma_f32_32x32x16_bf16 v[120:135], v[36:39], v[44:47], v[120:135]
    ds_read_b128 v[32:35], v66 offset:0
    ds_read_b128 v[36:39], v66 offset:4096
    ds_read_b128 v[40:43], v70 offset:0
    ds_read_b128 v[44:47], v70 offset:4096
    s_waitcnt lgkmcnt(4)
    v_mfma_f32_32x32x16_bf16 v[72:87], v[48:51], v[56:59], v[72:87]
    v_mfma_f32_32x32x16_bf16 v[88:103], v[48:51], v[60:63], v[88:103]
    v_mfma_f32_32x32x16_bf16 v[104:119], v[52:55], v[56:59], v[104:119]
    v_mfma_f32_32x32x16_bf16 v[120:135], v[52:55], v[60:63], v[120:135]
    ds_read_b128 v[48:51], v67 offset:0
    ds_read_b128 v[52:55], v67 offset:4096
    ds_read_b128 v[56:59], v71 offset:0
    ds_read_b128 v[60:63], v71 offset:4096
    s_waitcnt lgkmcnt(4)
    v_mfma_f32_32x32x16_bf16 v[72:87], v[32:35], v[40:43], v[72:87]
    v_mfma_f32_32x32x16_bf16 v[88:103], v[32:35], v[44:47], v[88:103]
    v_mfma_f32_32x32x16_bf16 v[104:119], v[36:39], v[40:43], v[104:119]
    v_mfma_f32_32x32x16_bf16 v[120:135], v[36:39], v[44:47], v[120:135]
    s_waitcnt lgkmcnt(0)
    v_mfma_f32_32x32x16_bf16 v[72:87], v[48:51], v[56:59], v[72:87]
    v_mfma_f32_32x32x16_bf16 v[88:103], v[48:51], v[60:63], v[88:103]
    v_mfma_f32_32x32x16_bf16 v[104:119], v[52:55], v[56:59], v[104:119]
    v_mfma_f32_32x32x16_bf16 v[120:135], v[52:55], v[60:63], v[120:135]
    s_waitcnt vmcnt(0)
    s_barrier
    s_mov_b32 s37, 1024
    s_add_u32 m0, s35, 0
    s_nop 0
    buffer_load_dwordx4 v8, s[8:11], s37 offen lds
    s_add_u32 m0, s35, 1024
    s_nop 0
    buffer_load_dwordx4 v9, s[8:11], s37 offen lds
    s_add_u32 m0, s35, 2048
    s_nop 0
    buffer_load_dwordx4 v10, s[8:11], s37 offen lds
    s_add_u32 m0, s35, 3072
    s_nop 0
    buffer_load_dwordx4 v11, s[8:11], s37 offen lds
    s_add_u32 m0, s36, 0
    s_nop 0
    buffer_load_dwordx4 v12, s[12:15], s37 offen lds
    s_add_u32 m0, s36, 1024
    s_nop 0
    buffer_load_dwordx4 v13, s[12:15], s37 offen lds
    s_add_u32 m0, s36, 2048
    s_nop 0
    buffer_load_dwordx4 v14, s[12:15], s37 offen lds
    s_add_u32 m0, s36, 3072
    s_nop 0
    buffer_load_dwordx4 v15, s[12:15], s37 offen lds
    ds_read_b128 v[32:35], v64 offset:32768
    ds_read_b128 v[36:39], v64 offset:36864
    ds_read_b128 v[40:43], v68 offset:32768
    ds_read_b128 v[44:47], v68 offset:36864
    ds_read_b128 v[48:51], v65 offset:32768
    ds_read_b128 v[52:55], v65 offset:36864
    ds_read_b128 v[56:59], v69 offset:32768
    ds_read_b128 v[60:63], v69 offset:36864
    s_waitcnt lgkmcnt(4)
    v_mfma_f32_32x32x16_bf16 v[72:87], v[32:35], v[40:43], v[72:87]
    v_mfma_f32_32x32x16_bf16 v[88:103], v[32:35], v[44:47], v[88:103]
    v_mfma_f32_32x32x16_bf16 v[104:119], v[36:39], v[40:43], v[104:119]
    v_mfma_f32_32x32x16_bf16 v[120:135], v[36:39], v[44:47], v[120:135]
    ds_read_b128 v[32:35], v66 offset:32768
    ds_read_b128 v[36:39], v66 offset:36864
    ds_read_b128 v[40:43], v70 offset:32768
    ds_read_b128 v[44:47], v70 offset:36864
    s_waitcnt lgkmcnt(4)
    v_mfma_f32_32x32x16_bf16 v[72:87], v[48:51], v[56:59], v[72:87]
    v_mfma_f32_32x32x16_bf16 v[88:103], v[48:51], v[60:63], v[88:103]
    v_mfma_f32_32x32x16_bf16 v[104:119], v[52:55], v[56:59], v[104:119]
    v_mfma_f32_32x32x16_bf16 v[120:135], v[52:55], v[60:63], v[120:135]
    ds_read_b128 v[48:51], v67 offset:32768
    ds_read_b128 v[52:55], v67 offset:36864
    ds_read_b128 v[56:59], v71 offset:32768
    ds_read_b128 v[60:63], v71 offset:36864
    s_waitcnt lgkmcnt(4)
    v_mfma_f32_32x32x16_bf16 v[72:87], v[32:35], v[40:43], v[72:87]
    v_mfma_f32_32x32x16_bf16 v[88:103], v[32:35], v[44:47], v[88:103]
    v_mfma_f32_32x32x16_bf16 v[104:119], v[36:39], v[40:43], v[104:119]
    v_mfma_f32_32x32x16_bf16 v[120:135], v[36:39], v[44:47], v[120:135]
    s_waitcnt lgkmcnt(0)
    v_mfma_f32_32x32x16_bf16 v[72:87], v[48:51], v[56:59], v[72:87]
    v_mfma_f32_32x32x16_bf16 v[88:103], v[48:51], v[60:63], v[88:103]
    v_mfma_f32_32x32x16_bf16 v[104:119], v[52:55], v[56:59], v[104:119]
    v_mfma_f32_32x32x16_bf16 v[120:135], v[52:55], v[60:63], v[120:135]
    s_waitcnt vmcnt(0)
    s_barrier
    s_mov_b32 s37, 1152
    s_add_u32 m0, s35, 32768
    s_nop 0
    buffer_load_dwordx4 v8, s[8:11], s37 offen lds
    s_add_u32 m0, s35, 33792
    s_nop 0
    buffer_load_dwordx4 v9, s[8:11], s37 offen lds
    s_add_u32 m0, s35, 34816
    s_nop 0
    buffer_load_dwordx4 v10, s[8:11], s37 offen lds
    s_add_u32 m0, s35, 35840
    s_nop 0
    buffer_load_dwordx4 v11, s[8:11], s37 offen lds
    s_add_u32 m0, s36, 32768
    s_nop 0
    buffer_load_dwordx4 v12, s[12:15], s37 offen lds
    s_add_u32 m0, s36, 33792
    s_nop 0
    buffer_load_dwordx4 v13, s[12:15], s37 offen lds
    s_add_u32 m0, s36, 34816
    s_nop 0
    buffer_load_dwordx4 v14, s[12:15], s37 offen lds
    s_add_u32 m0, s36, 35840
    s_nop 0
    buffer_load_dwordx4 v15, s[12:15], s37 offen lds
    ds_read_b128 v[32:35], v64 offset:0
    ds_read_b128 v[36:39], v64 offset:4096
    ds_read_b128 v[40:43], v68 offset:0
    ds_read_b128 v[44:47], v68 offset:4096
    ds_read_b128 v[48:51], v65 offset:0
    ds_read_b128 v[52:55], v65 offset:4096
    ds_read_b128 v[56:59], v69 offset:0
    ds_read_b128 v[60:63], v69 offset:4096
    s_waitcnt lgkmcnt(4)
    v_mfma_f32_32x32x16_bf16 v[72:87], v[32:35], v[40:43], v[72:87]
    v_mfma_f32_32x32x16_bf16 v[88:103], v[32:35], v[44:47], v[88:103]
    v_mfma_f32_32x32x16_bf16 v[104:119], v[36:39], v[40:43], v[104:119]
    v_mfma_f32_32x32x16_bf16 v[120:135], v[36:39], v[44:47], v[120:135]
    ds_read_b128 v[32:35], v66 offset:0
    ds_read_b128 v[36:39], v66 offset:4096
    ds_read_b128 v[40:43], v70 offset:0
    ds_read_b128 v[44:47], v70 offset:4096
    s_waitcnt lgkmcnt(4)
    v_mfma_f32_32x32x16_bf16 v[72:87], v[48:51], v[56:59], v[72:87]
    v_mfma_f32_32x32x16_bf16 v[88:103], v[48:51], v[60:63], v[88:103]
    v_mfma_f32_32x32x16_bf16 v[104:119], v[52:55], v[56:59], v[104:119]
    v_mfma_f32_32x32x16_bf16 v[120:135], v[52:55], v[60:63], v[120:135]
    ds_read_b128 v[48:51], v67 offset:0
    ds_read_b128 v[52:55], v67 offset:4096
    ds_read_b128 v[56:59], v71 offset:0
    ds_read_b128 v[60:63], v71 offset:4096
    s_waitcnt lgkmcnt(4)
    v_mfma_f32_32x32x16_bf16 v[72:87], v[32:35], v[40:43], v[72:87]
    v_mfma_f32_32x32x16_bf16 v[88:103], v[32:35], v[44:47], v[88:103]
    v_mfma_f32_32x32x16_bf16 v[104:119], v[36:39], v[40:43], v[104:119]
    v_mfma_f32_32x32x16_bf16 v[120:135], v[36:39], v[44:47], v[120:135]
    s_waitcnt lgkmcnt(0)
    v_mfma_f32_32x32x16_bf16 v[72:87], v[48:51], v[56:59], v[72:87]
    v_mfma_f32_32x32x16_bf16 v[88:103], v[48:51], v[60:63], v[88:103]
    v_mfma_f32_32x32x16_bf16 v[104:119], v[52:55], v[56:59], v[104:119]
    v_mfma_f32_32x32x16_bf16 v[120:135], v[52:55], v[60:63], v[120:135]
    s_waitcnt vmcnt(0)
    s_barrier
    ds_read_b128 v[32:35], v64 offset:32768
    ds_read_b128 v[36:39], v64 offset:36864
    ds_read_b128 v[40:43], v68 offset:32768
    ds_read_b128 v[44:47], v68 offset:36864
    ds_read_b128 v[48:51], v65 offset:32768
    ds_read_b128 v[52:55], v65 offset:36864
    ds_read_b128 v[56:59], v69 offset:32768
    ds_read_b128 v[60:63], v69 offset:36864
    s_waitcnt lgkmcnt(4)
    v_mfma_f32_32x32x16_bf16 v[72:87], v[32:35], v[40:43], v[72:87]
    v_mfma_f32_32x32x16_bf16 v[88:103], v[32:35], v[44:47], v[88:103]
    v_mfma_f32_32x32x16_bf16 v[104:119], v[36:39], v[40:43], v[104:119]
    v_mfma_f32_32x32x16_bf16 v[120:135], v[36:39], v[44:47], v[120:135]
    ds_read_b128 v[32:35], v66 offset:32768
    ds_read_b128 v[36:39], v66 offset:36864
    ds_read_b128 v[40:43], v70 offset:32768
    ds_read_b128 v[44:47], v70 offset:36864
    s_waitcnt lgkmcnt(4)
    v_mfma_f32_32x32x16_bf16 v[72:87], v[48:51], v[56:59], v[72:87]
    v_mfma_f32_32x32x16_bf16 v[88:103], v[48:51], v[60:63], v[88:103]
    v_mfma_f32_32x32x16_bf16 v[104:119], v[52:55], v[56:59], v[104:119]
    v_mfma_f32_32x32x16_bf16 v[120:135], v[52:55], v[60:63], v[120:135]
    ds_read_b128 v[48:51], v67 offset:32768
    ds_read_b128 v[52:55], v67 offset:36864
    ds_read_b128 v[56:59], v71 offset:32768
    ds_read_b128 v[60:63], v71 offset:36864
    s_waitcnt lgkmcnt(4)
    v_mfma_f32_32x32x16_bf16 v[72:87], v[32:35], v[40:43], v[72:87]
    v_mfma_f32_32x32x16_bf16 v[88:103], v[32:35], v[44:47], v[88:103]
    v_mfma_f32_32x32x16_bf16 v[104:119], v[36:39], v[40:43], v[104:119]
    v_mfma_f32_32x32x16_bf16 v[120:135], v[36:39], v[44:47], v[120:135]
    s_waitcnt lgkmcnt(0)
    v_mfma_f32_32x32x16_bf16 v[72:87], v[48:51], v[56:59], v[72:87]
    v_mfma_f32_32x32x16_bf16 v[88:103], v[48:51], v[60:63], v[88:103]
    v_mfma_f32_32x32x16_bf16 v[104:119], v[52:55], v[56:59], v[104:119]
    v_mfma_f32_32x32x16_bf16 v[120:135], v[52:55], v[60:63], v[120:135]
    s_nop 7
    s_nop 7
    s_add_u32 s16, s40, 11927552
    s_addc_u32 s17, s41, 0
    s_mov_b32 s18, 7077888
    s_mov_b32 s19, 0x00020000
    v_and_b32 v3, 31, v1
    v_lshrrev_b32 v4, 5, v1
    v_and_b32 v7, 1, v2
    v_lshrrev_b32 v6, 1, v2
    v_mul_u32_u24 v5, 64, v7
    v_add_u32 v5, v5, v3
    v_add_u32 v5, s7, v5
    v_mul_u32_u24 v5, 3456, v5
    s_lshr_b32 s3, s6, 1
    v_lshlrev_b32 v6, 5, v6
    v_add_u32 v6, s3, v6
    v_lshlrev_b32 v4, 2, v4
    v_add_u32 v6, v6, v4
    v_lshlrev_b32 v6, 1, v6
    v_add_u32 v5, v5, v6
    s_mov_b32 s3, 0xbfb8aa3b
    v_cvt_pk_bf16_f32 v72, v72, v72
    v_lshlrev_b32 v72, 16, v72
    v_cvt_pk_bf16_f32 v104, v104, v104
    v_lshlrev_b32 v104, 16, v104
    v_mul_f32 v24, s3, v72
    v_exp_f32 v24, v24
    s_nop 0
    v_add_f32 v24, 1.0, v24
    v_rcp_f32 v24, v24
    s_nop 0
    v_cvt_pk_bf16_f32 v24, v24, v24
    v_lshlrev_b32 v24, 16, v24
    v_mul_f32 v28, v24, v104
    v_cvt_pk_bf16_f32 v73, v73, v73
    v_lshlrev_b32 v73, 16, v73
    v_cvt_pk_bf16_f32 v105, v105, v105
    v_lshlrev_b32 v105, 16, v105
    v_mul_f32 v24, s3, v73
    v_exp_f32 v24, v24
    s_nop 0
    v_add_f32 v24, 1.0, v24
    v_rcp_f32 v24, v24
    s_nop 0
    v_cvt_pk_bf16_f32 v24, v24, v24
    v_lshlrev_b32 v24, 16, v24
    v_mul_f32 v29, v24, v105
    v_cvt_pk_bf16_f32 v74, v74, v74
    v_lshlrev_b32 v74, 16, v74
    v_cvt_pk_bf16_f32 v106, v106, v106
    v_lshlrev_b32 v106, 16, v106
    v_mul_f32 v24, s3, v74
    v_exp_f32 v24, v24
    s_nop 0
    v_add_f32 v24, 1.0, v24
    v_rcp_f32 v24, v24
    s_nop 0
    v_cvt_pk_bf16_f32 v24, v24, v24
    v_lshlrev_b32 v24, 16, v24
    v_mul_f32 v30, v24, v106
    v_cvt_pk_bf16_f32 v75, v75, v75
    v_lshlrev_b32 v75, 16, v75
    v_cvt_pk_bf16_f32 v107, v107, v107
    v_lshlrev_b32 v107, 16, v107
    v_mul_f32 v24, s3, v75
    v_exp_f32 v24, v24
    s_nop 0
    v_add_f32 v24, 1.0, v24
    v_rcp_f32 v24, v24
    s_nop 0
    v_cvt_pk_bf16_f32 v24, v24, v24
    v_lshlrev_b32 v24, 16, v24
    v_mul_f32 v31, v24, v107
    v_cvt_pk_bf16_f32 v26, v28, v29
    v_cvt_pk_bf16_f32 v27, v30, v31
    s_mov_b32 s4, 0
    buffer_store_dwordx2 v[26:27], v5, s[16:19], s4 offen offset:0
    v_cvt_pk_bf16_f32 v76, v76, v76
    v_lshlrev_b32 v76, 16, v76
    v_cvt_pk_bf16_f32 v108, v108, v108
    v_lshlrev_b32 v108, 16, v108
    v_mul_f32 v24, s3, v76
    v_exp_f32 v24, v24
    s_nop 0
    v_add_f32 v24, 1.0, v24
    v_rcp_f32 v24, v24
    s_nop 0
    v_cvt_pk_bf16_f32 v24, v24, v24
    v_lshlrev_b32 v24, 16, v24
    v_mul_f32 v28, v24, v108
    v_cvt_pk_bf16_f32 v77, v77, v77
    v_lshlrev_b32 v77, 16, v77
    v_cvt_pk_bf16_f32 v109, v109, v109
    v_lshlrev_b32 v109, 16, v109
    v_mul_f32 v24, s3, v77
    v_exp_f32 v24, v24
    s_nop 0
    v_add_f32 v24, 1.0, v24
    v_rcp_f32 v24, v24
    s_nop 0
    v_cvt_pk_bf16_f32 v24, v24, v24
    v_lshlrev_b32 v24, 16, v24
    v_mul_f32 v29, v24, v109
    v_cvt_pk_bf16_f32 v78, v78, v78
    v_lshlrev_b32 v78, 16, v78
    v_cvt_pk_bf16_f32 v110, v110, v110
    v_lshlrev_b32 v110, 16, v110
    v_mul_f32 v24, s3, v78
    v_exp_f32 v24, v24
    s_nop 0
    v_add_f32 v24, 1.0, v24
    v_rcp_f32 v24, v24
    s_nop 0
    v_cvt_pk_bf16_f32 v24, v24, v24
    v_lshlrev_b32 v24, 16, v24
    v_mul_f32 v30, v24, v110
    v_cvt_pk_bf16_f32 v79, v79, v79
    v_lshlrev_b32 v79, 16, v79
    v_cvt_pk_bf16_f32 v111, v111, v111
    v_lshlrev_b32 v111, 16, v111
    v_mul_f32 v24, s3, v79
    v_exp_f32 v24, v24
    s_nop 0
    v_add_f32 v24, 1.0, v24
    v_rcp_f32 v24, v24
    s_nop 0
    v_cvt_pk_bf16_f32 v24, v24, v24
    v_lshlrev_b32 v24, 16, v24
    v_mul_f32 v31, v24, v111
    v_cvt_pk_bf16_f32 v26, v28, v29
    v_cvt_pk_bf16_f32 v27, v30, v31
    s_mov_b32 s4, 0
    buffer_store_dwordx2 v[26:27], v5, s[16:19], s4 offen offset:16
    v_cvt_pk_bf16_f32 v80, v80, v80
    v_lshlrev_b32 v80, 16, v80
    v_cvt_pk_bf16_f32 v112, v112, v112
    v_lshlrev_b32 v112, 16, v112
    v_mul_f32 v24, s3, v80
    v_exp_f32 v24, v24
    s_nop 0
    v_add_f32 v24, 1.0, v24
    v_rcp_f32 v24, v24
    s_nop 0
    v_cvt_pk_bf16_f32 v24, v24, v24
    v_lshlrev_b32 v24, 16, v24
    v_mul_f32 v28, v24, v112
    v_cvt_pk_bf16_f32 v81, v81, v81
    v_lshlrev_b32 v81, 16, v81
    v_cvt_pk_bf16_f32 v113, v113, v113
    v_lshlrev_b32 v113, 16, v113
    v_mul_f32 v24, s3, v81
    v_exp_f32 v24, v24
    s_nop 0
    v_add_f32 v24, 1.0, v24
    v_rcp_f32 v24, v24
    s_nop 0
    v_cvt_pk_bf16_f32 v24, v24, v24
    v_lshlrev_b32 v24, 16, v24
    v_mul_f32 v29, v24, v113
    v_cvt_pk_bf16_f32 v82, v82, v82
    v_lshlrev_b32 v82, 16, v82
    v_cvt_pk_bf16_f32 v114, v114, v114
    v_lshlrev_b32 v114, 16, v114
    v_mul_f32 v24, s3, v82
    v_exp_f32 v24, v24
    s_nop 0
    v_add_f32 v24, 1.0, v24
    v_rcp_f32 v24, v24
    s_nop 0
    v_cvt_pk_bf16_f32 v24, v24, v24
    v_lshlrev_b32 v24, 16, v24
    v_mul_f32 v30, v24, v114
    v_cvt_pk_bf16_f32 v83, v83, v83
    v_lshlrev_b32 v83, 16, v83
    v_cvt_pk_bf16_f32 v115, v115, v115
    v_lshlrev_b32 v115, 16, v115
    v_mul_f32 v24, s3, v83
    v_exp_f32 v24, v24
    s_nop 0
    v_add_f32 v24, 1.0, v24
    v_rcp_f32 v24, v24
    s_nop 0
    v_cvt_pk_bf16_f32 v24, v24, v24
    v_lshlrev_b32 v24, 16, v24
    v_mul_f32 v31, v24, v115
    v_cvt_pk_bf16_f32 v26, v28, v29
    v_cvt_pk_bf16_f32 v27, v30, v31
    s_mov_b32 s4, 0
    buffer_store_dwordx2 v[26:27], v5, s[16:19], s4 offen offset:32
    v_cvt_pk_bf16_f32 v84, v84, v84
    v_lshlrev_b32 v84, 16, v84
    v_cvt_pk_bf16_f32 v116, v116, v116
    v_lshlrev_b32 v116, 16, v116
    v_mul_f32 v24, s3, v84
    v_exp_f32 v24, v24
    s_nop 0
    v_add_f32 v24, 1.0, v24
    v_rcp_f32 v24, v24
    s_nop 0
    v_cvt_pk_bf16_f32 v24, v24, v24
    v_lshlrev_b32 v24, 16, v24
    v_mul_f32 v28, v24, v116
    v_cvt_pk_bf16_f32 v85, v85, v85
    v_lshlrev_b32 v85, 16, v85
    v_cvt_pk_bf16_f32 v117, v117, v117
    v_lshlrev_b32 v117, 16, v117
    v_mul_f32 v24, s3, v85
    v_exp_f32 v24, v24
    s_nop 0
    v_add_f32 v24, 1.0, v24
    v_rcp_f32 v24, v24
    s_nop 0
    v_cvt_pk_bf16_f32 v24, v24, v24
    v_lshlrev_b32 v24, 16, v24
    v_mul_f32 v29, v24, v117
    v_cvt_pk_bf16_f32 v86, v86, v86
    v_lshlrev_b32 v86, 16, v86
    v_cvt_pk_bf16_f32 v118, v118, v118
    v_lshlrev_b32 v118, 16, v118
    v_mul_f32 v24, s3, v86
    v_exp_f32 v24, v24
    s_nop 0
    v_add_f32 v24, 1.0, v24
    v_rcp_f32 v24, v24
    s_nop 0
    v_cvt_pk_bf16_f32 v24, v24, v24
    v_lshlrev_b32 v24, 16, v24
    v_mul_f32 v30, v24, v118
    v_cvt_pk_bf16_f32 v87, v87, v87
    v_lshlrev_b32 v87, 16, v87
    v_cvt_pk_bf16_f32 v119, v119, v119
    v_lshlrev_b32 v119, 16, v119
    v_mul_f32 v24, s3, v87
    v_exp_f32 v24, v24
    s_nop 0
    v_add_f32 v24, 1.0, v24
    v_rcp_f32 v24, v24
    s_nop 0
    v_cvt_pk_bf16_f32 v24, v24, v24
    v_lshlrev_b32 v24, 16, v24
    v_mul_f32 v31, v24, v119
    v_cvt_pk_bf16_f32 v26, v28, v29
    v_cvt_pk_bf16_f32 v27, v30, v31
    s_mov_b32 s4, 0
    buffer_store_dwordx2 v[26:27], v5, s[16:19], s4 offen offset:48
    v_cvt_pk_bf16_f32 v88, v88, v88
    v_lshlrev_b32 v88, 16, v88
    v_cvt_pk_bf16_f32 v120, v120, v120
    v_lshlrev_b32 v120, 16, v120
    v_mul_f32 v24, s3, v88
    v_exp_f32 v24, v24
    s_nop 0
    v_add_f32 v24, 1.0, v24
    v_rcp_f32 v24, v24
    s_nop 0
    v_cvt_pk_bf16_f32 v24, v24, v24
    v_lshlrev_b32 v24, 16, v24
    v_mul_f32 v28, v24, v120
    v_cvt_pk_bf16_f32 v89, v89, v89
    v_lshlrev_b32 v89, 16, v89
    v_cvt_pk_bf16_f32 v121, v121, v121
    v_lshlrev_b32 v121, 16, v121
    v_mul_f32 v24, s3, v89
    v_exp_f32 v24, v24
    s_nop 0
    v_add_f32 v24, 1.0, v24
    v_rcp_f32 v24, v24
    s_nop 0
    v_cvt_pk_bf16_f32 v24, v24, v24
    v_lshlrev_b32 v24, 16, v24
    v_mul_f32 v29, v24, v121
    v_cvt_pk_bf16_f32 v90, v90, v90
    v_lshlrev_b32 v90, 16, v90
    v_cvt_pk_bf16_f32 v122, v122, v122
    v_lshlrev_b32 v122, 16, v122
    v_mul_f32 v24, s3, v90
    v_exp_f32 v24, v24
    s_nop 0
    v_add_f32 v24, 1.0, v24
    v_rcp_f32 v24, v24
    s_nop 0
    v_cvt_pk_bf16_f32 v24, v24, v24
    v_lshlrev_b32 v24, 16, v24
    v_mul_f32 v30, v24, v122
    v_cvt_pk_bf16_f32 v91, v91, v91
    v_lshlrev_b32 v91, 16, v91
    v_cvt_pk_bf16_f32 v123, v123, v123
    v_lshlrev_b32 v123, 16, v123
    v_mul_f32 v24, s3, v91
    v_exp_f32 v24, v24
    s_nop 0
    v_add_f32 v24, 1.0, v24
    v_rcp_f32 v24, v24
    s_nop 0
    v_cvt_pk_bf16_f32 v24, v24, v24
    v_lshlrev_b32 v24, 16, v24
    v_mul_f32 v31, v24, v123
    v_cvt_pk_bf16_f32 v26, v28, v29
    v_cvt_pk_bf16_f32 v27, v30, v31
    s_mov_b32 s4, 110592
    buffer_store_dwordx2 v[26:27], v5, s[16:19], s4 offen offset:0
    v_cvt_pk_bf16_f32 v92, v92, v92
    v_lshlrev_b32 v92, 16, v92
    v_cvt_pk_bf16_f32 v124, v124, v124
    v_lshlrev_b32 v124, 16, v124
    v_mul_f32 v24, s3, v92
    v_exp_f32 v24, v24
    s_nop 0
    v_add_f32 v24, 1.0, v24
    v_rcp_f32 v24, v24
    s_nop 0
    v_cvt_pk_bf16_f32 v24, v24, v24
    v_lshlrev_b32 v24, 16, v24
    v_mul_f32 v28, v24, v124
    v_cvt_pk_bf16_f32 v93, v93, v93
    v_lshlrev_b32 v93, 16, v93
    v_cvt_pk_bf16_f32 v125, v125, v125
    v_lshlrev_b32 v125, 16, v125
    v_mul_f32 v24, s3, v93
    v_exp_f32 v24, v24
    s_nop 0
    v_add_f32 v24, 1.0, v24
    v_rcp_f32 v24, v24
    s_nop 0
    v_cvt_pk_bf16_f32 v24, v24, v24
    v_lshlrev_b32 v24, 16, v24
    v_mul_f32 v29, v24, v125
    v_cvt_pk_bf16_f32 v94, v94, v94
    v_lshlrev_b32 v94, 16, v94
    v_cvt_pk_bf16_f32 v126, v126, v126
    v_lshlrev_b32 v126, 16, v126
    v_mul_f32 v24, s3, v94
    v_exp_f32 v24, v24
    s_nop 0
    v_add_f32 v24, 1.0, v24
    v_rcp_f32 v24, v24
    s_nop 0
    v_cvt_pk_bf16_f32 v24, v24, v24
    v_lshlrev_b32 v24, 16, v24
    v_mul_f32 v30, v24, v126
    v_cvt_pk_bf16_f32 v95, v95, v95
    v_lshlrev_b32 v95, 16, v95
    v_cvt_pk_bf16_f32 v127, v127, v127
    v_lshlrev_b32 v127, 16, v127
    v_mul_f32 v24, s3, v95
    v_exp_f32 v24, v24
    s_nop 0
    v_add_f32 v24, 1.0, v24
    v_rcp_f32 v24, v24
    s_nop 0
    v_cvt_pk_bf16_f32 v24, v24, v24
    v_lshlrev_b32 v24, 16, v24
    v_mul_f32 v31, v24, v127
    v_cvt_pk_bf16_f32 v26, v28, v29
    v_cvt_pk_bf16_f32 v27, v30, v31
    s_mov_b32 s4, 110592
    buffer_store_dwordx2 v[26:27], v5, s[16:19], s4 offen offset:16
    v_cvt_pk_bf16_f32 v96, v96, v96
    v_lshlrev_b32 v96, 16, v96
    v_cvt_pk_bf16_f32 v128, v128, v128
    v_lshlrev_b32 v128, 16, v128
    v_mul_f32 v24, s3, v96
    v_exp_f32 v24, v24
    s_nop 0
    v_add_f32 v24, 1.0, v24
    v_rcp_f32 v24, v24
    s_nop 0
    v_cvt_pk_bf16_f32 v24, v24, v24
    v_lshlrev_b32 v24, 16, v24
    v_mul_f32 v28, v24, v128
    v_cvt_pk_bf16_f32 v97, v97, v97
    v_lshlrev_b32 v97, 16, v97
    v_cvt_pk_bf16_f32 v129, v129, v129
    v_lshlrev_b32 v129, 16, v129
    v_mul_f32 v24, s3, v97
    v_exp_f32 v24, v24
    s_nop 0
    v_add_f32 v24, 1.0, v24
    v_rcp_f32 v24, v24
    s_nop 0
    v_cvt_pk_bf16_f32 v24, v24, v24
    v_lshlrev_b32 v24, 16, v24
    v_mul_f32 v29, v24, v129
    v_cvt_pk_bf16_f32 v98, v98, v98
    v_lshlrev_b32 v98, 16, v98
    v_cvt_pk_bf16_f32 v130, v130, v130
    v_lshlrev_b32 v130, 16, v130
    v_mul_f32 v24, s3, v98
    v_exp_f32 v24, v24
    s_nop 0
    v_add_f32 v24, 1.0, v24
    v_rcp_f32 v24, v24
    s_nop 0
    v_cvt_pk_bf16_f32 v24, v24, v24
    v_lshlrev_b32 v24, 16, v24
    v_mul_f32 v30, v24, v130
    v_cvt_pk_bf16_f32 v99, v99, v99
    v_lshlrev_b32 v99, 16, v99
    v_cvt_pk_bf16_f32 v131, v131, v131
    v_lshlrev_b32 v131, 16, v131
    v_mul_f32 v24, s3, v99
    v_exp_f32 v24, v24
    s_nop 0
    v_add_f32 v24, 1.0, v24
    v_rcp_f32 v24, v24
    s_nop 0
    v_cvt_pk_bf16_f32 v24, v24, v24
    v_lshlrev_b32 v24, 16, v24
    v_mul_f32 v31, v24, v131
    v_cvt_pk_bf16_f32 v26, v28, v29
    v_cvt_pk_bf16_f32 v27, v30, v31
    s_mov_b32 s4, 110592
    buffer_store_dwordx2 v[26:27], v5, s[16:19], s4 offen offset:32
    v_cvt_pk_bf16_f32 v100, v100, v100
    v_lshlrev_b32 v100, 16, v100
    v_cvt_pk_bf16_f32 v132, v132, v132
    v_lshlrev_b32 v132, 16, v132
    v_mul_f32 v24, s3, v100
    v_exp_f32 v24, v24
    s_nop 0
    v_add_f32 v24, 1.0, v24
    v_rcp_f32 v24, v24
    s_nop 0
    v_cvt_pk_bf16_f32 v24, v24, v24
    v_lshlrev_b32 v24, 16, v24
    v_mul_f32 v28, v24, v132
    v_cvt_pk_bf16_f32 v101, v101, v101
    v_lshlrev_b32 v101, 16, v101
    v_cvt_pk_bf16_f32 v133, v133, v133
    v_lshlrev_b32 v133, 16, v133
    v_mul_f32 v24, s3, v101
    v_exp_f32 v24, v24
    s_nop 0
    v_add_f32 v24, 1.0, v24
    v_rcp_f32 v24, v24
    s_nop 0
    v_cvt_pk_bf16_f32 v24, v24, v24
    v_lshlrev_b32 v24, 16, v24
    v_mul_f32 v29, v24, v133
    v_cvt_pk_bf16_f32 v102, v102, v102
    v_lshlrev_b32 v102, 16, v102
    v_cvt_pk_bf16_f32 v134, v134, v134
    v_lshlrev_b32 v134, 16, v134
    v_mul_f32 v24, s3, v102
    v_exp_f32 v24, v24
    s_nop 0
    v_add_f32 v24, 1.0, v24
    v_rcp_f32 v24, v24
    s_nop 0
    v_cvt_pk_bf16_f32 v24, v24, v24
    v_lshlrev_b32 v24, 16, v24
    v_mul_f32 v30, v24, v134
    v_cvt_pk_bf16_f32 v103, v103, v103
    v_lshlrev_b32 v103, 16, v103
    v_cvt_pk_bf16_f32 v135, v135, v135
    v_lshlrev_b32 v135, 16, v135
    v_mul_f32 v24, s3, v103
    v_exp_f32 v24, v24
    s_nop 0
    v_add_f32 v24, 1.0, v24
    v_rcp_f32 v24, v24
    s_nop 0
    v_cvt_pk_bf16_f32 v24, v24, v24
    v_lshlrev_b32 v24, 16, v24
    v_mul_f32 v31, v24, v135
    v_cvt_pk_bf16_f32 v26, v28, v29
    v_cvt_pk_bf16_f32 v27, v30, v31
    s_mov_b32 s4, 110592
    buffer_store_dwordx2 v[26:27], v5, s[16:19], s4 offen offset:48
gemm1_end:
    s_endpgm
mix_convbody:
    s_mov_b32 s33, s2
    s_load_dwordx4 s[36:39], s[0:1], 32
    s_load_dwordx2 s[40:41], s[0:1], 96
    s_cmp_ge_u32 s33, 640
    s_cbranch_scc1 conv_end
    s_waitcnt lgkmcnt(0)
    s_lshl_b32 s3, s33, 12
    s_add_u32 s8, s36, s3
    s_addc_u32 s9, s37, 0
    s_mov_b32 s10, 4096
    s_mov_b32 s11, 0x00020000
    s_add_u32 s12, s40, 2621440
    s_addc_u32 s13, s41, 0
    s_add_u32 s12, s12, s3
    s_addc_u32 s13, s13, 0
    s_mov_b32 s14, 4096
    s_mov_b32 s15, 0x00020000
    s_add_u32 s16, s40, 19005440
    s_addc_u32 s17, s41, 0
    s_add_u32 s16, s16, s3
    s_addc_u32 s17, s17, 0
    s_mov_b32 s18, 4096
    s_mov_b32 s19, 0x00020000
    s_mov_b32 s20, s38
    s_mov_b32 s21, s39
    s_mov_b32 s22, 1280
    s_mov_b32 s23, 0x00020000
    v_lshlrev_b32 v1, 4, v0
    buffer_load_dwordx4 v[8:11], v1, s[8:11], 0 offen
    buffer_load_dwordx4 v[12:15], v1, s[8:11], 0 offen offset:16
    buffer_load_dwordx4 v[16:19], v1, s[12:15], 0 offen
    v_mov_b32 v2, s33
    v_lshlrev_b32 v2, 1, v2
    buffer_load_ushort v3, v2, s[20:23], 0 offen
    v_add_u32 v4, 128, v1
    v_lshrrev_b32 v5, 3, v0
    v_mul_u32_u24 v5, 144, v5
    v_and_b32 v6, 7, v0
    v_lshlrev_b32 v6, 4, v6
    v_add_u32 v5, v5, v6
    v_mov_b32 v28, 0
    v_mov_b32 v29, 0
    v_mov_b32 v30, 0
    v_mov_b32 v31, 0
    ds_write_b128 v5, v[28:31] offset:39936
    s_waitcnt vmcnt(1)
    ds_write_b128 v5, v[16:19] offset:35328
    ds_write_b128 v4, v[8:11] offset:0
    v_alignbyte_b32 v24, v9, v8, 2
    v_alignbyte_b32 v25, v10, v9, 2
    v_alignbyte_b32 v26, v11, v10, 2
    v_alignbyte_b32 v27, v12, v11, 2
    ds_write_b128 v4, v[24:27] offset:4416
    v_mov_b32 v20, v9
    v_mov_b32 v21, v10
    v_mov_b32 v22, v11
    v_mov_b32 v23, v12
    ds_write_b128 v4, v[20:23] offset:8832
    v_alignbyte_b32 v24, v10, v9, 2
    v_alignbyte_b32 v25, v11, v10, 2
    v_alignbyte_b32 v26, v12, v11, 2
    v_alignbyte_b32 v27, v13, v12, 2
    ds_write_b128 v4, v[24:27] offset:13248
    ds_write_b128 v4, v[10:13] offset:17664
    v_alignbyte_b32 v24, v11, v10, 2
    v_alignbyte_b32 v25, v12, v11, 2
    v_alignbyte_b32 v26, v13, v12, 2
    v_alignbyte_b32 v27, v14, v13, 2
    ds_write_b128 v4, v[24:27] offset:22080
    v_mov_b32 v20, v11
    v_mov_b32 v21, v12
    v_mov_b32 v22, v13
    v_mov_b32 v23, v14
    ds_write_b128 v4, v[20:23] offset:26496
    v_alignbyte_b32 v24, v12, v11, 2
    v_alignbyte_b32 v25, v13, v12, 2
    v_alignbyte_b32 v26, v14, v13, 2
    v_alignbyte_b32 v27, v15, v14, 2
    ds_write_b128 v4, v[24:27] offset:30912
    v_cmp_gt_u32 vcc, 8, v0
    s_and_saveexec_b64 s[24:25], vcc
    s_cbranch_execz conv_headdone
    v_subrev_u32 v7, 128, v1
    buffer_load_dwordx4 v[8:11], v7, s[8:11], 0 offen
    buffer_load_dwordx4 v[12:15], v7, s[8:11], 0 offen offset:16
    s_waitcnt vmcnt(0)
    ds_write_b128 v1, v[8:11] offset:0
    v_alignbyte_b32 v24, v9, v8, 2
    v_alignbyte_b32 v25, v10, v9, 2
    v_alignbyte_b32 v26, v11, v10, 2
    v_alignbyte_b32 v27, v12, v11, 2
    ds_write_b128 v1, v[24:27] offset:4416
    v_mov_b32 v20, v9
    v_mov_b32 v21, v10
    v_mov_b32 v22, v11
    v_mov_b32 v23, v12
    ds_write_b128 v1, v[20:23] offset:8832
    v_alignbyte_b32 v24, v10, v9, 2
    v_alignbyte_b32 v25, v11, v10, 2
    v_alignbyte_b32 v26, v12, v11, 2
    v_alignbyte_b32 v27, v13, v12, 2
    ds_write_b128 v1, v[24:27] offset:13248
    ds_write_b128 v1, v[10:13] offset:17664
    v_alignbyte_b32 v24, v11, v10, 2
    v_alignbyte_b32 v25, v12, v11, 2
    v_alignbyte_b32 v26, v13, v12, 2
    v_alignbyte_b32 v27, v14, v13, 2
    ds_write_b128 v1, v[24:27] offset:22080
    v_mov_b32 v20, v11
    v_mov_b32 v21, v12
    v_mov_b32 v22, v13
    v_mov_b32 v23, v14
    ds_write_b128 v1, v[20:23] offset:26496
    v_alignbyte_b32 v24, v12, v11, 2
    v_alignbyte_b32 v25, v13, v12, 2
    v_alignbyte_b32 v26, v14, v13, 2
    v_alignbyte_b32 v27, v15, v14, 2
    ds_write_b128 v1, v[24:27] offset:30912
conv_headdone:
    s_mov_b64 exec, s[24:25]
    v_and_b32 v8, 63, v0
    v_lshrrev_b32 v9, 6, v0
    v_and_b32 v10, 31, v8
    v_lshrrev_b32 v11, 5, v8
    v_add_u32 v12, 1, v10
    v_and_b32 v13, 7, v12
    v_lshrrev_b32 v12, 3, v12
    v_mul_u32_u24 v13, 4416, v13
    v_add_u32 v12, v12, v11
    v_lshlrev_b32 v12, 4, v12
    v_add_u32 v13, v13, v12
    v_lshlrev_b32 v12, 10, v9
    v_add_u32 v40, v13, v12
    v_sub_u32 v12, 31, v10
    v_mul_u32_u24 v12, 144, v12
    v_lshlrev_b32 v13, 4, v11
    v_add_u32 v12, v12, v13
    v_mul_u32_u24 v13, 1152, v9
    v_add_u32 v41, v12, v13
    v_mov_b32 v96, 0
    v_mov_b32 v97, 0
    v_mov_b32 v98, 0
    v_mov_b32 v99, 0
    v_mov_b32 v100, 0
    v_mov_b32 v101, 0
    v_mov_b32 v102, 0
    v_mov_b32 v103, 0
    v_mov_b32 v104, 0
    v_mov_b32 v105, 0
    v_mov_b32 v106, 0
    v_mov_b32 v107, 0
    v_mov_b32 v108, 0
    v_mov_b32 v109, 0
    v_mov_b32 v110, 0
    v_mov_b32 v111, 0
    v_mov_b32 v112, 0
    v_mov_b32 v113, 0
    v_mov_b32 v114, 0
    v_mov_b32 v115, 0
    v_mov_b32 v116, 0
    v_mov_b32 v117, 0
    v_mov_b32 v118, 0
    v_mov_b32 v119, 0
    v_mov_b32 v120, 0
    v_mov_b32 v121, 0
    v_mov_b32 v122, 0
    v_mov_b32 v123, 0
    v_mov_b32 v124, 0
    v_mov_b32 v125, 0
    v_mov_b32 v126, 0
    v_mov_b32 v127, 0
    s_waitcnt lgkmcnt(0)
    s_barrier
    ds_read_b128 v[48:51], v40 offset:0
    ds_read_b128 v[80:83], v41 offset:35328
    ds_read_b128 v[52:55], v40 offset:32
    ds_read_b128 v[56:59], v40 offset:64
    ds_read_b128 v[84:87], v41 offset:35360
    ds_read_b128 v[60:63], v40 offset:96
    ds_read_b128 v[64:67], v40 offset:128
    ds_read_b128 v[88:91], v41 offset:35392
    s_waitcnt lgkmcnt(4)
    v_mfma_f32_32x32x16_bf16 v[96:111], v[48:51], v[80:83], v[96:111]
    v_mfma_f32_32x32x16_bf16 v[112:127], v[56:59], v[80:83], v[112:127]
    ds_read_b128 v[68:71], v40 offset:160
    ds_read_b128 v[92:95], v41 offset:35424
    s_waitcnt lgkmcnt(4)
    v_mfma_f32_32x32x16_bf16 v[96:111], v[52:55], v[84:87], v[96:111]
    v_mfma_f32_32x32x16_bf16 v[112:127], v[60:63], v[84:87], v[112:127]
    ds_read_b128 v[48:51], v40 offset:192
    ds_read_b128 v[80:83], v41 offset:35472
    s_waitcnt lgkmcnt(4)
    v_mfma_f32_32x32x16_bf16 v[96:111], v[56:59], v[88:91], v[96:111]
    v_mfma_f32_32x32x16_bf16 v[112:127], v[64:67], v[88:91], v[112:127]
    ds_read_b128 v[52:55], v40 offset:224
    ds_read_b128 v[84:87], v41 offset:35504
    s_waitcnt lgkmcnt(4)
    v_mfma_f32_32x32x16_bf16 v[96:111], v[60:63], v[92:95], v[96:111]
    v_mfma_f32_32x32x16_bf16 v[112:127], v[68:71], v[92:95], v[112:127]
    ds_read_b128 v[56:59], v40 offset:256
    ds_read_b128 v[88:91], v41 offset:35536
    s_waitcnt lgkmcnt(4)
    v_mfma_f32_32x32x16_bf16 v[96:111], v[64:67], v[80:83], v[96:111]
    v_mfma_f32_32x32x16_bf16 v[112:127], v[48:51], v[80:83], v[112:127]
    ds_read_b128 v[60:63], v40 offset:288
    ds_read_b128 v[92:95], v41 offset:35568
    s_waitcnt lgkmcnt(4)
    v_mfma_f32_32x32x16_bf16 v[96:111], v[68:71], v[84:87], v[96:111]
    v_mfma_f32_32x32x16_bf16 v[112:127], v[52:55], v[84:87], v[112:127]
    ds_read_b128 v[64:67], v40 offset:320
    ds_read_b128 v[80:83], v41 offset:35616
    s_waitcnt lgkmcnt(4)
    v_mfma_f32_32x32x16_bf16 v[96:111], v[48:51], v[88:91], v[96:111]
    v_mfma_f32_32x32x16_bf16 v[112:127], v[56:59], v[88:91], v[112:127]
    ds_read_b128 v[68:71], v40 offset:352
    ds_read_b128 v[84:87], v41 offset:35648
    s_waitcnt lgkmcnt(4)
    v_mfma_f32_32x32x16_bf16 v[96:111], v[52:55], v[92:95], v[96:111]
    v_mfma_f32_32x32x16_bf16 v[112:127], v[60:63], v[92:95], v[112:127]
    ds_read_b128 v[48:51], v40 offset:384
    ds_read_b128 v[88:91], v41 offset:35680
    s_waitcnt lgkmcnt(4)
    v_mfma_f32_32x32x16_bf16 v[96:111], v[56:59], v[80:83], v[96:111]
    v_mfma_f32_32x32x16_bf16 v[112:127], v[64:67], v[80:83], v[112:127]
    ds_read_b128 v[52:55], v40 offset:416
    ds_read_b128 v[92:95], v41 offset:35712
    s_waitcnt lgkmcnt(4)
    v_mfma_f32_32x32x16_bf16 v[96:111], v[60:63], v[84:87], v[96:111]
    v_mfma_f32_32x32x16_bf16 v[112:127], v[68:71], v[84:87], v[112:127]
    ds_read_b128 v[56:59], v40 offset:448
    ds_read_b128 v[80:83], v41 offset:35760
    s_waitcnt lgkmcnt(4)
    v_mfma_f32_32x32x16_bf16 v[96:111], v[64:67], v[88:91], v[96:111]
    v_mfma_f32_32x32x16_bf16 v[112:127], v[48:51], v[88:91], v[112:127]
    ds_read_b128 v[60:63], v40 offset:480
    ds_read_b128 v[84:87], v41 offset:35792
    s_waitcnt lgkmcnt(4)
    v_mfma_f32_32x32x16_bf16 v[96:111], v[68:71], v[92:95], v[96:111]
    v_mfma_f32_32x32x16_bf16 v[112:127], v[52:55], v[92:95], v[112:127]
    ds_read_b128 v[64:67], v40 offset:512
    ds_read_b128 v[88:91], v41 offset:35824
    s_waitcnt lgkmcnt(4)
    v_mfma_f32_32x32x16_bf16 v[96:111], v[48:51], v[80:83], v[96:111]
    v_mfma_f32_32x32x16_bf16 v[112:127], v[56:59], v[80:83], v[112:127]
    ds_read_b128 v[68:71], v40 offset:544
    ds_read_b128 v[92:95], v41 offset:35856
    s_waitcnt lgkmcnt(4)
    v_mfma_f32_32x32x16_bf16 v[96:111], v[52:55], v[84:87], v[96:111]
    v_mfma_f32_32x32x16_bf16 v[112:127], v[60:63], v[84:87], v[112:127]
    ds_read_b128 v[48:51], v40 offset:576
    ds_read_b128 v[80:83], v41 offset:35904
    s_waitcnt lgkmcnt(4)
    v_mfma_f32_32x32x16_bf16 v[96:111], v[56:59], v[88:91], v[96:111]
    v_mfma_f32_32x32x16_bf16 v[112:127], v[64:67], v[88:91], v[112:127]
    ds_read_b128 v[52:55], v40 offset:608
    ds_read_b128 v[84:87], v41 offset:35936
    s_waitcnt lgkmcnt(4)
    v_mfma_f32_32x32x16_bf16 v[96:111], v[60:63], v[92:95], v[96:111]
    v_mfma_f32_32x32x16_bf16 v[112:127], v[68:71], v[92:95], v[112:127]
    ds_read_b128 v[56:59], v40 offset:640
    ds_read_b128 v[88:91], v41 offset:35968
    s_waitcnt lgkmcnt(4)
    v_mfma_f32_32x32x16_bf16 v[96:111], v[64:67], v[80:83], v[96:111]
    v_mfma_f32_32x32x16_bf16 v[112:127], v[48:51], v[80:83], v[112:127]
    ds_read_b128 v[60:63], v40 offset:672
    ds_read_b128 v[92:95], v41 offset:36000
    s_waitcnt lgkmcnt(4)
    v_mfma_f32_32x32x16_bf16 v[96:111], v[68:71], v[84:87], v[96:111]
    v_mfma_f32_32x32x16_bf16 v[112:127], v[52:55], v[84:87], v[112:127]
    ds_read_b128 v[64:67], v40 offset:704
    ds_read_b128 v[80:83], v41 offset:36048
    s_waitcnt lgkmcnt(4)
    v_mfma_f32_32x32x16_bf16 v[96:111], v[48:51], v[88:91], v[96:111]
    v_mfma_f32_32x32x16_bf16 v[112:127], v[56:59], v[88:91], v[112:127]
    ds_read_b128 v[68:71], v40 offset:736
    ds_read_b128 v[84:87], v41 offset:36080
    s_waitcnt lgkmcnt(4)
    v_mfma_f32_32x32x16_bf16 v[96:111], v[52:55], v[92:95], v[96:111]
    v_mfma_f32_32x32x16_bf16 v[112:127], v[60:63], v[92:95], v[112:127]
    ds_read_b128 v[48:51], v40 offset:768
    ds_read_b128 v[88:91], v41 offset:36112
    s_waitcnt lgkmcnt(4)
    v_mfma_f32_32x32x16_bf16 v[96:111], v[56:59], v[80:83], v[96:111]
    v_mfma_f32_32x32x16_bf16 v[112:127], v[64:67], v[80:83], v[112:127]
    ds_read_b128 v[52:55], v40 offset:800
    ds_read_b128 v[92:95], v41 offset:36144
    s_waitcnt lgkmcnt(4)
    v_mfma_f32_32x32x16_bf16 v[96:111], v[60:63], v[84:87], v[96:111]
    v_mfma_f32_32x32x16_bf16 v[112:127], v[68:71], v[84:87], v[112:127]
    ds_read_b128 v[56:59], v40 offset:832
    ds_read_b128 v[80:83], v41 offset:36192
    s_waitcnt lgkmcnt(4)
    v_mfma_f32_32x32x16_bf16 v[96:111], v[64:67], v[88:91], v[96:111]
    v_mfma_f32_32x32x16_bf16 v[112:127], v[48:51], v[88:91], v[112:127]
    ds_read_b128 v[60:63], v40 offset:864
    ds_read_b128 v[84:87], v41 offset:36224
    s_waitcnt lgkmcnt(4)
    v_mfma_f32_32x32x16_bf16 v[96:111], v[68:71], v[92:95], v[96:111]
    v_mfma_f32_32x32x16_bf16 v[112:127], v[52:55], v[92:95], v[112:127]
    ds_read_b128 v[64:67], v40 offset:896
    ds_read_b128 v[88:91], v41 offset:36256
    s_waitcnt lgkmcnt(4)
    v_mfma_f32_32x32x16_bf16 v[96:111], v[48:51], v[80:83], v[96:111]
    v_mfma_f32_32x32x16_bf16 v[112:127], v[56:59], v[80:83], v[112:127]
    ds_read_b128 v[68:71], v40 offset:928
    ds_read_b128 v[92:95], v41 offset:36288
    s_waitcnt lgkmcnt(4)
    v_mfma_f32_32x32x16_bf16 v[96:111], v[52:55], v[84:87], v[96:111]
    v_mfma_f32_32x32x16_bf16 v[112:127], v[60:63], v[84:87], v[112:127]
    ds_read_b128 v[48:51], v40 offset:960
    ds_read_b128 v[80:83], v41 offset:36336
    s_waitcnt lgkmcnt(4)
    v_mfma_f32_32x32x16_bf16 v[96:111], v[56:59], v[88:91], v[96:111]
    v_mfma_f32_32x32x16_bf16 v[112:127], v[64:67], v[88:91], v[112:127]
    ds_read_b128 v[52:55], v40 offset:992
    ds_read_b128 v[84:87], v41 offset:36368
    s_waitcnt lgkmcnt(4)
    v_mfma_f32_32x32x16_bf16 v[96:111], v[60:63], v[92:95], v[96:111]
    v_mfma_f32_32x32x16_bf16 v[112:127], v[68:71], v[92:95], v[112:127]
    ds_read_b128 v[56:59], v40 offset:1024
    ds_read_b128 v[88:91], v41 offset:36400
    s_waitcnt lgkmcnt(4)
    v_mfma_f32_32x32x16_bf16 v[96:111], v[64:67], v[80:83], v[96:111]
    v_mfma_f32_32x32x16_bf16 v[112:127], v[48:51], v[80:83], v[112:127]
    ds_read_b128 v[60:63], v40 offset:1056
    ds_read_b128 v[92:95], v41 offset:36432
    s_waitcnt lgkmcnt(4)
    v_mfma_f32_32x32x16_bf16 v[96:111], v[68:71], v[84:87], v[96:111]
    v_mfma_f32_32x32x16_bf16 v[112:127], v[52:55], v[84:87], v[112:127]
    s_waitcnt lgkmcnt(2)
    v_mfma_f32_32x32x16_bf16 v[96:111], v[48:51], v[88:91], v[96:111]
    v_mfma_f32_32x32x16_bf16 v[112:127], v[56:59], v[88:91], v[112:127]
    s_waitcnt lgkmcnt(0)
    v_mfma_f32_32x32x16_bf16 v[96:111], v[52:55], v[92:95], v[96:111]
    v_mfma_f32_32x32x16_bf16 v[112:127], v[60:63], v[92:95], v[112:127]
    s_barrier
    v_lshlrev_b32 v12, 13, v9
    v_lshlrev_b32 v13, 4, v8
    v_add_u32 v12, v12, v13
    s_nop 7
    s_nop 3
    ds_write_b128 v12, v[96:99] offset:0
    ds_write_b128 v12, v[100:103] offset:1024
    ds_write_b128 v12, v[104:107] offset:2048
    ds_write_b128 v12, v[108:111] offset:3072
    ds_write_b128 v12, v[112:115] offset:4096
    ds_write_b128 v12, v[116:119] offset:5120
    ds_write_b128 v12, v[120:123] offset:6144
    ds_write_b128 v12, v[124:127] offset:7168
    s_waitcnt lgkmcnt(0)
    s_barrier
    v_lshlrev_b32 v3, 16, v3
    v_lshlrev_b32 v12, 4, v0
    ds_read_b128 v[48:51], v12 offset:0
    ds_read_b128 v[52:55], v12 offset:8192
    ds_read_b128 v[56:59], v12 offset:16384
    ds_read_b128 v[60:63], v12 offset:24576
    v_lshrrev_b32 v14, 6, v0
    v_lshlrev_b32 v14, 3, v14
    v_lshlrev_b32 v15, 2, v11
    v_add_u32 v14, v14, v15
    v_lshlrev_b32 v15, 6, v10
    v_add_u32 v14, v14, v15
    v_sub_u32 v15, 2044, v14
    v_lshrrev_b32 v16, 6, v15
    v_mul_u32_u24 v16, 144, v16
    v_and_b32 v15, 63, v15
    v_lshlrev_b32 v15, 1, v15
    v_add_u32 v15, v15, v16
    ds_read_b64 v[64:65], v15 offset:35328
    s_waitcnt lgkmcnt(1)
    v_add_f32 v48, v48, v52
    v_add_f32 v56, v56, v60
    v_add_f32 v48, v48, v56
    v_add_f32 v49, v49, v53
    v_add_f32 v57, v57, v61
    v_add_f32 v49, v49, v57
    v_add_f32 v50, v50, v54
    v_add_f32 v58, v58, v62
    v_add_f32 v50, v50, v58
    v_add_f32 v51, v51, v55
    v_add_f32 v59, v59, v63
    v_add_f32 v51, v51, v59
    s_waitcnt lgkmcnt(0)
    v_and_b32 v20, 0xffff0000, v65
    v_mul_f32 v20, v20, v3
    v_cvt_pk_bf16_f32 v20, v20, v20
    v_lshlrev_b32 v20, 16, v20
    v_cvt_pk_bf16_f32 v48, v48, v48
    v_lshlrev_b32 v48, 16, v48
    v_add_f32 v48, v48, v20
    v_lshlrev_b32 v20, 16, v65
    v_mul_f32 v20, v20, v3
    v_cvt_pk_bf16_f32 v20, v20, v20
    v_lshlrev_b32 v20, 16, v20
    v_cvt_pk_bf16_f32 v49, v49, v49
    v_lshlrev_b32 v49, 16, v49
    v_add_f32 v49, v49, v20
    v_and_b32 v20, 0xffff0000, v64
    v_mul_f32 v20, v20, v3
    v_cvt_pk_bf16_f32 v20, v20, v20
    v_lshlrev_b32 v20, 16, v20
    v_cvt_pk_bf16_f32 v50, v50, v50
    v_lshlrev_b32 v50, 16, v50
    v_add_f32 v50, v50, v20
    v_lshlrev_b32 v20, 16, v64
    v_mul_f32 v20, v20, v3
    v_cvt_pk_bf16_f32 v20, v20, v20
    v_lshlrev_b32 v20, 16, v20
    v_cvt_pk_bf16_f32 v51, v51, v51
    v_lshlrev_b32 v51, 16, v51
    v_add_f32 v51, v51, v20
    v_cvt_pk_bf16_f32 v48, v48, v49
    v_cvt_pk_bf16_f32 v49, v50, v51
    v_lshlrev_b32 v14, 1, v14
    buffer_store_dwordx2 v[48:49], v14, s[16:19], 0 offen
    v_lshlrev_b32 v12, 4, v0
    ds_read_b128 v[48:51], v12 offset:4096
    ds_read_b128 v[52:55], v12 offset:12288
    ds_read_b128 v[56:59], v12 offset:20480
    ds_read_b128 v[60:63], v12 offset:28672
    v_lshrrev_b32 v14, 6, v0
    v_add_u32 v14, 4, v14
    v_lshlrev_b32 v14, 3, v14
    v_lshlrev_b32 v15, 2, v11
    v_add_u32 v14, v14, v15
    v_lshlrev_b32 v15, 6, v10
    v_add_u32 v14, v14, v15
    v_sub_u32 v15, 2044, v14
    v_lshrrev_b32 v16, 6, v15
    v_mul_u32_u24 v16, 144, v16
    v_and_b32 v15, 63, v15
    v_lshlrev_b32 v15, 1, v15
    v_add_u32 v15, v15, v16
    ds_read_b64 v[64:65], v15 offset:35328
    s_waitcnt lgkmcnt(1)
    v_add_f32 v48, v48, v52
    v_add_f32 v56, v56, v60
    v_add_f32 v48, v48, v56
    v_add_f32 v49, v49, v53
    v_add_f32 v57, v57, v61
    v_add_f32 v49, v49, v57
    v_add_f32 v50, v50, v54
    v_add_f32 v58, v58, v62
    v_add_f32 v50, v50, v58
    v_add_f32 v51, v51, v55
    v_add_f32 v59, v59, v63
    v_add_f32 v51, v51, v59
    s_waitcnt lgkmcnt(0)
    v_and_b32 v20, 0xffff0000, v65
    v_mul_f32 v20, v20, v3
    v_cvt_pk_bf16_f32 v20, v20, v20
    v_lshlrev_b32 v20, 16, v20
    v_cvt_pk_bf16_f32 v48, v48, v48
    v_lshlrev_b32 v48, 16, v48
    v_add_f32 v48, v48, v20
    v_lshlrev_b32 v20, 16, v65
    v_mul_f32 v20, v20, v3
    v_cvt_pk_bf16_f32 v20, v20, v20
    v_lshlrev_b32 v20, 16, v20
    v_cvt_pk_bf16_f32 v49, v49, v49
    v_lshlrev_b32 v49, 16, v49
    v_add_f32 v49, v49, v20
    v_and_b32 v20, 0xffff0000, v64
    v_mul_f32 v20, v20, v3
    v_cvt_pk_bf16_f32 v20, v20, v20
    v_lshlrev_b32 v20, 16, v20
    v_cvt_pk_bf16_f32 v50, v50, v50
    v_lshlrev_b32 v50, 16, v50
    v_add_f32 v50, v50, v20
    v_lshlrev_b32 v20, 16, v64
    v_mul_f32 v20, v20, v3
    v_cvt_pk_bf16_f32 v20, v20, v20
    v_lshlrev_b32 v20, 16, v20
    v_cvt_pk_bf16_f32 v51, v51, v51
    v_lshlrev_b32 v51, 16, v51
    v_add_f32 v51, v51, v20
    v_cvt_pk_bf16_f32 v48, v48, v49
    v_cvt_pk_bf16_f32 v49, v50, v51
    v_lshlrev_b32 v14, 1, v14
    buffer_store_dwordx2 v[48:49], v14, s[16:19], 0 offen
conv_end:
    s_endpgm
.section .rodata,"a"
.p2align 6
.amdhsa_kernel mix_kernel
  .amdhsa_next_free_vgpr 144
  .amdhsa_next_free_sgpr 64
  .amdhsa_accum_offset 144
  .amdhsa_group_segment_fixed_size 0
  .amdhsa_kernarg_size 104
  .amdhsa_user_sgpr_count 2
  .amdhsa_user_sgpr_kernarg_segment_ptr 1
  .amdhsa_system_sgpr_workgroup_id_x 1
.end_amdhsa_kernel
.text

.globl gemm2_kernel
.p2align 8
.type gemm2_kernel,@function
gemm2_kernel:
    s_mov_b32 s33, s2
    s_load_dwordx2 s[40:41], s[0:1], 96
    s_load_dwordx2 s[42:43], s[0:1], 0
    s_load_dwordx2 s[44:45], s[0:1], 80
    s_load_dwordx2 s[46:47], s[0:1], 40
    s_cmp_ge_u32 s33, 160
    s_cbranch_scc1 gemm2_end
    s_and_b32 s38, s33, 7
    s_lshr_b32 s39, s33, 3
    s_mul_i32 s5, s39, 64
    s_lshr_b32 s5, s5, 8
    s_mul_i32 s3, s5, 4
    s_sub_u32 s4, s39, s3
    s_mul_i32 s38, s38, 4
    s_add_u32 s4, s4, s38
    s_waitcnt lgkmcnt(0)
    s_add_u32 s8, s40, 9699328
    s_addc_u32 s9, s41, 0
    s_mov_b32 s10, 2211840
    s_mov_b32 s11, 0x00020000
    s_add_u32 s12, s40, 11927552
    s_addc_u32 s13, s41, 0
    s_mov_b32 s14, 7077888
    s_mov_b32 s15, 0x00020000
    s_mul_i32 s6, s5, 128
    s_mul_i32 s7, s4, 64
    v_and_b32 v1, 63, v0
    v_lshrrev_b32 v2, 6, v0
    s_nop 0
    v_readfirstlane_b32 s34, v2
    v_lshrrev_b32 v3, 3, v1
    v_and_b32 v4, 7, v1
    v_lshrrev_b32 v5, 4, v1
    v_mul_u32_u24 v6, 32, v2
    v_add_u32 v6, 0, v6
    v_add_u32 v6, v6, v3
    v_add_u32 v6, s6, v6
    v_mul_u32_u24 v6, 3456, v6
    v_add_u32 v7, 0, v5
    v_and_b32 v7, 7, v7
    v_xor_b32 v7, v7, v4
    v_lshlrev_b32 v7, 4, v7
    v_add_u32 v8, v6, v7
    v_mul_u32_u24 v6, 32, v2
    v_add_u32 v6, 8, v6
    v_add_u32 v6, v6, v3
    v_add_u32 v6, s6, v6
    v_mul_u32_u24 v6, 3456, v6
    v_add_u32 v7, 4, v5
    v_and_b32 v7, 7, v7
    v_xor_b32 v7, v7, v4
    v_lshlrev_b32 v7, 4, v7
    v_add_u32 v9, v6, v7
    v_mul_u32_u24 v6, 32, v2
    v_add_u32 v6, 16, v6
    v_add_u32 v6, v6, v3
    v_add_u32 v6, s6, v6
    v_mul_u32_u24 v6, 3456, v6
    v_add_u32 v7, 8, v5
    v_and_b32 v7, 7, v7
    v_xor_b32 v7, v7, v4
    v_lshlrev_b32 v7, 4, v7
    v_add_u32 v10, v6, v7
    v_mul_u32_u24 v6, 32, v2
    v_add_u32 v6, 24, v6
    v_add_u32 v6, v6, v3
    v_add_u32 v6, s6, v6
    v_mul_u32_u24 v6, 3456, v6
    v_add_u32 v7, 12, v5
    v_and_b32 v7, 7, v7
    v_xor_b32 v7, v7, v4
    v_lshlrev_b32 v7, 4, v7
    v_add_u32 v11, v6, v7
    v_mul_u32_u24 v6, 16, v2
    v_add_u32 v6, 0, v6
    v_add_u32 v6, v6, v3
    v_add_u32 v6, s7, v6
    v_mul_u32_u24 v6, 3456, v6
    v_add_u32 v7, 0, v5
    v_and_b32 v7, 7, v7
    v_xor_b32 v7, v7, v4
    v_lshlrev_b32 v7, 4, v7
    v_add_u32 v12, v6, v7
    v_mul_u32_u24 v6, 16, v2
    v_add_u32 v6, 8, v6
    v_add_u32 v6, v6, v3
    v_add_u32 v6, s7, v6
    v_mul_u32_u24 v6, 3456, v6
    v_add_u32 v7, 4, v5
    v_and_b32 v7, 7, v7
    v_xor_b32 v7, v7, v4
    v_lshlrev_b32 v7, 4, v7
    v_add_u32 v13, v6, v7
    s_mul_i32 s35, s34, 4096
    s_mul_i32 s36, s34, 2048
    s_add_u32 s36, s36, 16384
    v_and_b32 v3, 31, v1
    v_lshrrev_b32 v4, 5, v1
    v_lshrrev_b32 v5, 1, v3
    v_and_b32 v5, 7, v5
    v_lshrrev_b32 v6, 1, v2
    v_and_b32 v7, 1, v2
    v_add_u32 v24, 0, v4
    v_xor_b32 v24, v24, v5
    v_lshlrev_b32 v24, 4, v24
    v_lshlrev_b32 v25, 7, v3
    v_add_u32 v24, v24, v25
    v_mul_u32_u24 v25, 8192, v6
    v_add_u32 v64, v24, v25
    v_mul_u32_u24 v25, 4096, v7
    v_add_u32 v25, 16384, v25
    v_add_u32 v68, v24, v25
    v_add_u32 v24, 2, v4
    v_xor_b32 v24, v24, v5
    v_lshlrev_b32 v24, 4, v24
    v_lshlrev_b32 v25, 7, v3
    v_add_u32 v24, v24, v25
    v_mul_u32_u24 v25, 8192, v6
    v_add_u32 v65, v24, v25
    v_mul_u32_u24 v25, 4096, v7
    v_add_u32 v25, 16384, v25
    v_add_u32 v69, v24, v25
    v_add_u32 v24, 4, v4
    v_xor_b32 v24, v24, v5
    v_lshlrev_b32 v24, 4, v24
    v_lshlrev_b32 v25, 7, v3
    v_add_u32 v24, v24, v25
    v_mul_u32_u24 v25, 8192, v6
    v_add_u32 v66, v24, v25
    v_mul_u32_u24 v25, 4096, v7
    v_add_u32 v25, 16384, v25
    v_add_u32 v70, v24, v25
    v_add_u32 v24, 6, v4
    v_xor_b32 v24, v24, v5
    v_lshlrev_b32 v24, 4, v24
    v_lshlrev_b32 v25, 7, v3
    v_add_u32 v24, v24, v25
    v_mul_u32_u24 v25, 8192, v6
    v_add_u32 v67, v24, v25
    v_mul_u32_u24 v25, 4096, v7
    v_add_u32 v25, 16384, v25
    v_add_u32 v71, v24, v25
    v_mov_b32 v72, 0
    v_mov_b32 v73, 0
    v_mov_b32 v74, 0
    v_mov_b32 v75, 0
    v_mov_b32 v76, 0
    v_mov_b32 v77, 0
    v_mov_b32 v78, 0
    v_mov_b32 v79, 0
    v_mov_b32 v80, 0
    v_mov_b32 v81, 0
    v_mov_b32 v82, 0
    v_mov_b32 v83, 0
    v_mov_b32 v84, 0
    v_mov_b32 v85, 0
    v_mov_b32 v86, 0
    v_mov_b32 v87, 0
    v_mov_b32 v88, 0
    v_mov_b32 v89, 0
    v_mov_b32 v90, 0
    v_mov_b32 v91, 0
    v_mov_b32 v92, 0
    v_mov_b32 v93, 0
    v_mov_b32 v94, 0
    v_mov_b32 v95, 0
    v_mov_b32 v96, 0
    v_mov_b32 v97, 0
    v_mov_b32 v98, 0
    v_mov_b32 v99, 0
    v_mov_b32 v100, 0
    v_mov_b32 v101, 0
    v_mov_b32 v102, 0
    v_mov_b32 v103, 0
    v_add_u32 v104, 0xc000, v64
    v_add_u32 v105, 0xc000, v65
    v_add_u32 v106, 0xc000, v66
    v_add_u32 v107, 0xc000, v67
    v_add_u32 v108, 0xc000, v68
    v_add_u32 v109, 0xc000, v69
    v_add_u32 v110, 0xc000, v70
    v_add_u32 v111, 0xc000, v71
    s_mov_b32 s37, 0
    s_add_u32 m0, s35, 0
    s_nop 0
    buffer_load_dwordx4 v8, s[8:11], s37 offen lds
    s_add_u32 m0, s35, 1024
    s_nop 0
    buffer_load_dwordx4 v9, s[8:11], s37 offen lds
    s_add_u32 m0, s35, 2048
    s_nop 0
    buffer_load_dwordx4 v10, s[8:11], s37 offen lds
    s_add_u32 m0, s35, 3072
    s_nop 0
    buffer_load_dwordx4 v11, s[8:11], s37 offen lds
    s_add_u32 m0, s36, 0
    s_nop 0
    buffer_load_dwordx4 v12, s[12:15], s37 offen lds
    s_add_u32 m0, s36, 1024
    s_nop 0
    buffer_load_dwordx4 v13, s[12:15], s37 offen lds
    s_mov_b32 s37, 128
    s_add_u32 m0, s35, 24576
    s_nop 0
    buffer_load_dwordx4 v8, s[8:11], s37 offen lds
    s_add_u32 m0, s35, 25600
    s_nop 0
    buffer_load_dwordx4 v9, s[8:11], s37 offen lds
    s_add_u32 m0, s35, 26624
    s_nop 0
    buffer_load_dwordx4 v10, s[8:11], s37 offen lds
    s_add_u32 m0, s35, 27648
    s_nop 0
    buffer_load_dwordx4 v11, s[8:11], s37 offen lds
    s_add_u32 m0, s36, 24576
    s_nop 0
    buffer_load_dwordx4 v12, s[12:15], s37 offen lds
    s_add_u32 m0, s36, 25600
    s_nop 0
    buffer_load_dwordx4 v13, s[12:15], s37 offen lds
    s_mov_b32 s37, 256
    s_add_u32 m0, s35, 49152
    s_nop 0
    buffer_load_dwordx4 v8, s[8:11], s37 offen lds
    s_add_u32 m0, s35, 50176
    s_nop 0
    buffer_load_dwordx4 v9, s[8:11], s37 offen lds
    s_add_u32 m0, s35, 51200
    s_nop 0
    buffer_load_dwordx4 v10, s[8:11], s37 offen lds
    s_add_u32 m0, s35, 52224
    s_nop 0
    buffer_load_dwordx4 v11, s[8:11], s37 offen lds
    s_add_u32 m0, s36, 49152
    s_nop 0
    buffer_load_dwordx4 v12, s[12:15], s37 offen lds
    s_add_u32 m0, s36, 50176
    s_nop 0
    buffer_load_dwordx4 v13, s[12:15], s37 offen lds
    s_waitcnt vmcnt(12)
    s_barrier
    s_mov_b32 s37, 384
    s_add_u32 m0, s35, 73728
    s_nop 0
    buffer_load_dwordx4 v8, s[8:11], s37 offen lds
    s_add_u32 m0, s35, 74752
    s_nop 0
    buffer_load_dwordx4 v9, s[8:11], s37 offen lds
    s_add_u32 m0, s35, 75776
    s_nop 0
    buffer_load_dwordx4 v10, s[8:11], s37 offen lds
    s_add_u32 m0, s35, 76800
    s_nop 0
    buffer_load_dwordx4 v11, s[8:11], s37 offen lds
    s_add_u32 m0, s36, 73728
    s_nop 0
    buffer_load_dwordx4 v12, s[12:15], s37 offen lds
    s_add_u32 m0, s36, 74752
    s_nop 0
    buffer_load_dwordx4 v13, s[12:15], s37 offen lds
    ds_read_b128 v[32:35], v64 offset:0
    ds_read_b128 v[36:39], v64 offset:4096
    ds_read_b128 v[40:43], v68 offset:0
    ds_read_b128 v[48:51], v65 offset:0
    ds_read_b128 v[52:55], v65 offset:4096
    ds_read_b128 v[56:59], v69 offset:0
    s_waitcnt lgkmcnt(3)
    v_mfma_f32_32x32x16_bf16 v[72:87], v[32:35], v[40:43], v[72:87]
    v_mfma_f32_32x32x16_bf16 v[88:103], v[36:39], v[40:43], v[88:103]
    ds_read_b128 v[32:35], v66 offset:0
    ds_read_b128 v[36:39], v66 offset:4096
    ds_read_b128 v[40:43], v70 offset:0
    s_waitcnt lgkmcnt(3)
    v_mfma_f32_32x32x16_bf16 v[72:87], v[48:51], v[56:59], v[72:87]
    v_mfma_f32_32x32x16_bf16 v[88:103], v[52:55], v[56:59], v[88:103]
    ds_read_b128 v[48:51], v67 offset:0
    ds_read_b128 v[52:55], v67 offset:4096
    ds_read_b128 v[56:59], v71 offset:0
    s_waitcnt lgkmcnt(3)
    v_mfma_f32_32x32x16_bf16 v[72:87], v[32:35], v[40:43], v[72:87]
    v_mfma_f32_32x32x16_bf16 v[88:103], v[36:39], v[40:43], v[88:103]
    s_waitcnt lgkmcnt(0)
    v_mfma_f32_32x32x16_bf16 v[72:87], v[48:51], v[56:59], v[72:87]
    v_mfma_f32_32x32x16_bf16 v[88:103], v[52:55], v[56:59], v[88:103]
    s_waitcnt vmcnt(12)
    s_barrier
    s_mov_b32 s37, 512
    s_add_u32 m0, s35, 0
    s_nop 0
    buffer_load_dwordx4 v8, s[8:11], s37 offen lds
    s_add_u32 m0, s35, 1024
    s_nop 0
    buffer_load_dwordx4 v9, s[8:11], s37 offen lds
    s_add_u32 m0, s35, 2048
    s_nop 0
    buffer_load_dwordx4 v10, s[8:11], s37 offen lds
    s_add_u32 m0, s35, 3072
    s_nop 0
    buffer_load_dwordx4 v11, s[8:11], s37 offen lds
    s_add_u32 m0, s36, 0
    s_nop 0
    buffer_load_dwordx4 v12, s[12:15], s37 offen lds
    s_add_u32 m0, s36, 1024
    s_nop 0
    buffer_load_dwordx4 v13, s[12:15], s37 offen lds
    ds_read_b128 v[32:35], v64 offset:24576
    ds_read_b128 v[36:39], v64 offset:28672
    ds_read_b128 v[40:43], v68 offset:24576
    ds_read_b128 v[48:51], v65 offset:24576
    ds_read_b128 v[52:55], v65 offset:28672
    ds_read_b128 v[56:59], v69 offset:24576
    s_waitcnt lgkmcnt(3)
    v_mfma_f32_32x32x16_bf16 v[72:87], v[32:35], v[40:43], v[72:87]
    v_mfma_f32_32x32x16_bf16 v[88:103], v[36:39], v[40:43], v[88:103]
    ds_read_b128 v[32:35], v66 offset:24576
    ds_read_b128 v[36:39], v66 offset:28672
    ds_read_b128 v[40:43], v70 offset:24576
    s_waitcnt lgkmcnt(3)
    v_mfma_f32_32x32x16_bf16 v[72:87], v[48:51], v[56:59], v[72:87]
    v_mfma_f32_32x32x16_bf16 v[88:103], v[52:55], v[56:59], v[88:103]
    ds_read_b128 v[48:51], v67 offset:24576
    ds_read_b128 v[52:55], v67 offset:28672
    ds_read_b128 v[56:59], v71 offset:24576
    s_waitcnt lgkmcnt(3)
    v_mfma_f32_32x32x16_bf16 v[72:87], v[32:35], v[40:43], v[72:87]
    v_mfma_f32_32x32x16_bf16 v[88:103], v[36:39], v[40:43], v[88:103]
    s_waitcnt lgkmcnt(0)
    v_mfma_f32_32x32x16_bf16 v[72:87], v[48:51], v[56:59], v[72:87]
    v_mfma_f32_32x32x16_bf16 v[88:103], v[52:55], v[56:59], v[88:103]
    s_waitcnt vmcnt(12)
    s_barrier
    s_mov_b32 s37, 640
    s_add_u32 m0, s35, 24576
    s_nop 0
    buffer_load_dwordx4 v8, s[8:11], s37 offen lds
    s_add_u32 m0, s35, 25600
    s_nop 0
    buffer_load_dwordx4 v9, s[8:11], s37 offen lds
    s_add_u32 m0, s35, 26624
    s_nop 0
    buffer_load_dwordx4 v10, s[8:11], s37 offen lds
    s_add_u32 m0, s35, 27648
    s_nop 0
    buffer_load_dwordx4 v11, s[8:11], s37 offen lds
    s_add_u32 m0, s36, 24576
    s_nop 0
    buffer_load_dwordx4 v12, s[12:15], s37 offen lds
    s_add_u32 m0, s36, 25600
    s_nop 0
    buffer_load_dwordx4 v13, s[12:15], s37 offen lds
    ds_read_b128 v[32:35], v104 offset:0
    ds_read_b128 v[36:39], v104 offset:4096
    ds_read_b128 v[40:43], v108 offset:0
    ds_read_b128 v[48:51], v105 offset:0
    ds_read_b128 v[52:55], v105 offset:4096
    ds_read_b128 v[56:59], v109 offset:0
    s_waitcnt lgkmcnt(3)
    v_mfma_f32_32x32x16_bf16 v[72:87], v[32:35], v[40:43], v[72:87]
    v_mfma_f32_32x32x16_bf16 v[88:103], v[36:39], v[40:43], v[88:103]
    ds_read_b128 v[32:35], v106 offset:0
    ds_read_b128 v[36:39], v106 offset:4096
    ds_read_b128 v[40:43], v110 offset:0
    s_waitcnt lgkmcnt(3)
    v_mfma_f32_32x32x16_bf16 v[72:87], v[48:51], v[56:59], v[72:87]
    v_mfma_f32_32x32x16_bf16 v[88:103], v[52:55], v[56:59], v[88:103]
    ds_read_b128 v[48:51], v107 offset:0
    ds_read_b128 v[52:55], v107 offset:4096
    ds_read_b128 v[56:59], v111 offset:0
    s_waitcnt lgkmcnt(3)
    v_mfma_f32_32x32x16_bf16 v[72:87], v[32:35], v[40:43], v[72:87]
    v_mfma_f32_32x32x16_bf16 v[88:103], v[36:39], v[40:43], v[88:103]
    s_waitcnt lgkmcnt(0)
    v_mfma_f32_32x32x16_bf16 v[72:87], v[48:51], v[56:59], v[72:87]
    v_mfma_f32_32x32x16_bf16 v[88:103], v[52:55], v[56:59], v[88:103]
    s_waitcnt vmcnt(12)
    s_barrier
    s_mov_b32 s37, 768
    s_add_u32 m0, s35, 49152
    s_nop 0
    buffer_load_dwordx4 v8, s[8:11], s37 offen lds
    s_add_u32 m0, s35, 50176
    s_nop 0
    buffer_load_dwordx4 v9, s[8:11], s37 offen lds
    s_add_u32 m0, s35, 51200
    s_nop 0
    buffer_load_dwordx4 v10, s[8:11], s37 offen lds
    s_add_u32 m0, s35, 52224
    s_nop 0
    buffer_load_dwordx4 v11, s[8:11], s37 offen lds
    s_add_u32 m0, s36, 49152
    s_nop 0
    buffer_load_dwordx4 v12, s[12:15], s37 offen lds
    s_add_u32 m0, s36, 50176
    s_nop 0
    buffer_load_dwordx4 v13, s[12:15], s37 offen lds
    ds_read_b128 v[32:35], v104 offset:24576
    ds_read_b128 v[36:39], v104 offset:28672
    ds_read_b128 v[40:43], v108 offset:24576
    ds_read_b128 v[48:51], v105 offset:24576
    ds_read_b128 v[52:55], v105 offset:28672
    ds_read_b128 v[56:59], v109 offset:24576
    s_waitcnt lgkmcnt(3)
    v_mfma_f32_32x32x16_bf16 v[72:87], v[32:35], v[40:43], v[72:87]
    v_mfma_f32_32x32x16_bf16 v[88:103], v[36:39], v[40:43], v[88:103]
    ds_read_b128 v[32:35], v106 offset:24576
    ds_read_b128 v[36:39], v106 offset:28672
    ds_read_b128 v[40:43], v110 offset:24576
    s_waitcnt lgkmcnt(3)
    v_mfma_f32_32x32x16_bf16 v[72:87], v[48:51], v[56:59], v[72:87]
    v_mfma_f32_32x32x16_bf16 v[88:103], v[52:55], v[56:59], v[88:103]
    ds_read_b128 v[48:51], v107 offset:24576
    ds_read_b128 v[52:55], v107 offset:28672
    ds_read_b128 v[56:59], v111 offset:24576
    s_waitcnt lgkmcnt(3)
    v_mfma_f32_32x32x16_bf16 v[72:87], v[32:35], v[40:43], v[72:87]
    v_mfma_f32_32x32x16_bf16 v[88:103], v[36:39], v[40:43], v[88:103]
    s_waitcnt lgkmcnt(0)
    v_mfma_f32_32x32x16_bf16 v[72:87], v[48:51], v[56:59], v[72:87]
    v_mfma_f32_32x32x16_bf16 v[88:103], v[52:55], v[56:59], v[88:103]
    s_waitcnt vmcnt(12)
    s_barrier
    s_mov_b32 s37, 896
    s_add_u32 m0, s35, 73728
    s_nop 0
    buffer_load_dwordx4 v8, s[8:11], s37 offen lds
    s_add_u32 m0, s35, 74752
    s_nop 0
    buffer_load_dwordx4 v9, s[8:11], s37 offen lds
    s_add_u32 m0, s35, 75776
    s_nop 0
    buffer_load_dwordx4 v10, s[8:11], s37 offen lds
    s_add_u32 m0, s35, 76800
    s_nop 0
    buffer_load_dwordx4 v11, s[8:11], s37 offen lds
    s_add_u32 m0, s36, 73728
    s_nop 0
    buffer_load_dwordx4 v12, s[12:15], s37 offen lds
    s_add_u32 m0, s36, 74752
    s_nop 0
    buffer_load_dwordx4 v13, s[12:15], s37 offen lds
    ds_read_b128 v[32:35], v64 offset:0
    ds_read_b128 v[36:39], v64 offset:4096
    ds_read_b128 v[40:43], v68 offset:0
    ds_read_b128 v[48:51], v65 offset:0
    ds_read_b128 v[52:55], v65 offset:4096
    ds_read_b128 v[56:59], v69 offset:0
    s_waitcnt lgkmcnt(3)
    v_mfma_f32_32x32x16_bf16 v[72:87], v[32:35], v[40:43], v[72:87]
    v_mfma_f32_32x32x16_bf16 v[88:103], v[36:39], v[40:43], v[88:103]
    ds_read_b128 v[32:35], v66 offset:0
    ds_read_b128 v[36:39], v66 offset:4096
    ds_read_b128 v[40:43], v70 offset:0
    s_waitcnt lgkmcnt(3)
    v_mfma_f32_32x32x16_bf16 v[72:87], v[48:51], v[56:59], v[72:87]
    v_mfma_f32_32x32x16_bf16 v[88:103], v[52:55], v[56:59], v[88:103]
    ds_read_b128 v[48:51], v67 offset:0
    ds_read_b128 v[52:55], v67 offset:4096
    ds_read_b128 v[56:59], v71 offset:0
    s_waitcnt lgkmcnt(3)
    v_mfma_f32_32x32x16_bf16 v[72:87], v[32:35], v[40:43], v[72:87]
    v_mfma_f32_32x32x16_bf16 v[88:103], v[36:39], v[40:43], v[88:103]
    s_waitcnt lgkmcnt(0)
    v_mfma_f32_32x32x16_bf16 v[72:87], v[48:51], v[56:59], v[72:87]
    v_mfma_f32_32x32x16_bf16 v[88:103], v[52:55], v[56:59], v[88:103]
    s_waitcnt vmcnt(12)
    s_barrier
    s_mov_b32 s37, 1024
    s_add_u32 m0, s35, 0
    s_nop 0
    buffer_load_dwordx4 v8, s[8:11], s37 offen lds
    s_add_u32 m0, s35, 1024
    s_nop 0
    buffer_load_dwordx4 v9, s[8:11], s37 offen lds
    s_add_u32 m0, s35, 2048
    s_nop 0
    buffer_load_dwordx4 v10, s[8:11], s37 offen lds
    s_add_u32 m0, s35, 3072
    s_nop 0
    buffer_load_dwordx4 v11, s[8:11], s37 offen lds
    s_add_u32 m0, s36, 0
    s_nop 0
    buffer_load_dwordx4 v12, s[12:15], s37 offen lds
    s_add_u32 m0, s36, 1024
    s_nop 0
    buffer_load_dwordx4 v13, s[12:15], s37 offen lds
    ds_read_b128 v[32:35], v64 offset:24576
    ds_read_b128 v[36:39], v64 offset:28672
    ds_read_b128 v[40:43], v68 offset:24576
    ds_read_b128 v[48:51], v65 offset:24576
    ds_read_b128 v[52:55], v65 offset:28672
    ds_read_b128 v[56:59], v69 offset:24576
    s_waitcnt lgkmcnt(3)
    v_mfma_f32_32x32x16_bf16 v[72:87], v[32:35], v[40:43], v[72:87]
    v_mfma_f32_32x32x16_bf16 v[88:103], v[36:39], v[40:43], v[88:103]
    ds_read_b128 v[32:35], v66 offset:24576
    ds_read_b128 v[36:39], v66 offset:28672
    ds_read_b128 v[40:43], v70 offset:24576
    s_waitcnt lgkmcnt(3)
    v_mfma_f32_32x32x16_bf16 v[72:87], v[48:51], v[56:59], v[72:87]
    v_mfma_f32_32x32x16_bf16 v[88:103], v[52:55], v[56:59], v[88:103]
    ds_read_b128 v[48:51], v67 offset:24576
    ds_read_b128 v[52:55], v67 offset:28672
    ds_read_b128 v[56:59], v71 offset:24576
    s_waitcnt lgkmcnt(3)
    v_mfma_f32_32x32x16_bf16 v[72:87], v[32:35], v[40:43], v[72:87]
    v_mfma_f32_32x32x16_bf16 v[88:103], v[36:39], v[40:43], v[88:103]
    s_waitcnt lgkmcnt(0)
    v_mfma_f32_32x32x16_bf16 v[72:87], v[48:51], v[56:59], v[72:87]
    v_mfma_f32_32x32x16_bf16 v[88:103], v[52:55], v[56:59], v[88:103]
    s_waitcnt vmcnt(12)
    s_barrier
    s_mov_b32 s37, 1152
    s_add_u32 m0, s35, 24576
    s_nop 0
    buffer_load_dwordx4 v8, s[8:11], s37 offen lds
    s_add_u32 m0, s35, 25600
    s_nop 0
    buffer_load_dwordx4 v9, s[8:11], s37 offen lds
    s_add_u32 m0, s35, 26624
    s_nop 0
    buffer_load_dwordx4 v10, s[8:11], s37 offen lds
    s_add_u32 m0, s35, 27648
    s_nop 0
    buffer_load_dwordx4 v11, s[8:11], s37 offen lds
    s_add_u32 m0, s36, 24576
    s_nop 0
    buffer_load_dwordx4 v12, s[12:15], s37 offen lds
    s_add_u32 m0, s36, 25600
    s_nop 0
    buffer_load_dwordx4 v13, s[12:15], s37 offen lds
    ds_read_b128 v[32:35], v104 offset:0
    ds_read_b128 v[36:39], v104 offset:4096
    ds_read_b128 v[40:43], v108 offset:0
    ds_read_b128 v[48:51], v105 offset:0
    ds_read_b128 v[52:55], v105 offset:4096
    ds_read_b128 v[56:59], v109 offset:0
    s_waitcnt lgkmcnt(3)
    v_mfma_f32_32x32x16_bf16 v[72:87], v[32:35], v[40:43], v[72:87]
    v_mfma_f32_32x32x16_bf16 v[88:103], v[36:39], v[40:43], v[88:103]
    ds_read_b128 v[32:35], v106 offset:0
    ds_read_b128 v[36:39], v106 offset:4096
    ds_read_b128 v[40:43], v110 offset:0
    s_waitcnt lgkmcnt(3)
    v_mfma_f32_32x32x16_bf16 v[72:87], v[48:51], v[56:59], v[72:87]
    v_mfma_f32_32x32x16_bf16 v[88:103], v[52:55], v[56:59], v[88:103]
    ds_read_b128 v[48:51], v107 offset:0
    ds_read_b128 v[52:55], v107 offset:4096
    ds_read_b128 v[56:59], v111 offset:0
    s_waitcnt lgkmcnt(3)
    v_mfma_f32_32x32x16_bf16 v[72:87], v[32:35], v[40:43], v[72:87]
    v_mfma_f32_32x32x16_bf16 v[88:103], v[36:39], v[40:43], v[88:103]
    s_waitcnt lgkmcnt(0)
    v_mfma_f32_32x32x16_bf16 v[72:87], v[48:51], v[56:59], v[72:87]
    v_mfma_f32_32x32x16_bf16 v[88:103], v[52:55], v[56:59], v[88:103]
    s_waitcnt vmcnt(12)
    s_barrier
    s_mov_b32 s37, 1280
    s_add_u32 m0, s35, 49152
    s_nop 0
    buffer_load_dwordx4 v8, s[8:11], s37 offen lds
    s_add_u32 m0, s35, 50176
    s_nop 0
    buffer_load_dwordx4 v9, s[8:11], s37 offen lds
    s_add_u32 m0, s35, 51200
    s_nop 0
    buffer_load_dwordx4 v10, s[8:11], s37 offen lds
    s_add_u32 m0, s35, 52224
    s_nop 0
    buffer_load_dwordx4 v11, s[8:11], s37 offen lds
    s_add_u32 m0, s36, 49152
    s_nop 0
    buffer_load_dwordx4 v12, s[12:15], s37 offen lds
    s_add_u32 m0, s36, 50176
    s_nop 0
    buffer_load_dwordx4 v13, s[12:15], s37 offen lds
    ds_read_b128 v[32:35], v104 offset:24576
    ds_read_b128 v[36:39], v104 offset:28672
    ds_read_b128 v[40:43], v108 offset:24576
    ds_read_b128 v[48:51], v105 offset:24576
    ds_read_b128 v[52:55], v105 offset:28672
    ds_read_b128 v[56:59], v109 offset:24576
    s_waitcnt lgkmcnt(3)
    v_mfma_f32_32x32x16_bf16 v[72:87], v[32:35], v[40:43], v[72:87]
    v_mfma_f32_32x32x16_bf16 v[88:103], v[36:39], v[40:43], v[88:103]
    ds_read_b128 v[32:35], v106 offset:24576
    ds_read_b128 v[36:39], v106 offset:28672
    ds_read_b128 v[40:43], v110 offset:24576
    s_waitcnt lgkmcnt(3)
    v_mfma_f32_32x32x16_bf16 v[72:87], v[48:51], v[56:59], v[72:87]
    v_mfma_f32_32x32x16_bf16 v[88:103], v[52:55], v[56:59], v[88:103]
    ds_read_b128 v[48:51], v107 offset:24576
    ds_read_b128 v[52:55], v107 offset:28672
    ds_read_b128 v[56:59], v111 offset:24576
    s_waitcnt lgkmcnt(3)
    v_mfma_f32_32x32x16_bf16 v[72:87], v[32:35], v[40:43], v[72:87]
    v_mfma_f32_32x32x16_bf16 v[88:103], v[36:39], v[40:43], v[88:103]
    s_waitcnt lgkmcnt(0)
    v_mfma_f32_32x32x16_bf16 v[72:87], v[48:51], v[56:59], v[72:87]
    v_mfma_f32_32x32x16_bf16 v[88:103], v[52:55], v[56:59], v[88:103]
    s_waitcnt vmcnt(12)
    s_barrier
    s_mov_b32 s37, 1408
    s_add_u32 m0, s35, 73728
    s_nop 0
    buffer_load_dwordx4 v8, s[8:11], s37 offen lds
    s_add_u32 m0, s35, 74752
    s_nop 0
    buffer_load_dwordx4 v9, s[8:11], s37 offen lds
    s_add_u32 m0, s35, 75776
    s_nop 0
    buffer_load_dwordx4 v10, s[8:11], s37 offen lds
    s_add_u32 m0, s35, 76800
    s_nop 0
    buffer_load_dwordx4 v11, s[8:11], s37 offen lds
    s_add_u32 m0, s36, 73728
    s_nop 0
    buffer_load_dwordx4 v12, s[12:15], s37 offen lds
    s_add_u32 m0, s36, 74752
    s_nop 0
    buffer_load_dwordx4 v13, s[12:15], s37 offen lds
    ds_read_b128 v[32:35], v64 offset:0
    ds_read_b128 v[36:39], v64 offset:4096
    ds_read_b128 v[40:43], v68 offset:0
    ds_read_b128 v[48:51], v65 offset:0
    ds_read_b128 v[52:55], v65 offset:4096
    ds_read_b128 v[56:59], v69 offset:0
    s_waitcnt lgkmcnt(3)
    v_mfma_f32_32x32x16_bf16 v[72:87], v[32:35], v[40:43], v[72:87]
    v_mfma_f32_32x32x16_bf16 v[88:103], v[36:39], v[40:43], v[88:103]
    ds_read_b128 v[32:35], v66 offset:0
    ds_read_b128 v[36:39], v66 offset:4096
    ds_read_b128 v[40:43], v70 offset:0
    s_waitcnt lgkmcnt(3)
    v_mfma_f32_32x32x16_bf16 v[72:87], v[48:51], v[56:59], v[72:87]
    v_mfma_f32_32x32x16_bf16 v[88:103], v[52:55], v[56:59], v[88:103]
    ds_read_b128 v[48:51], v67 offset:0
    ds_read_b128 v[52:55], v67 offset:4096
    ds_read_b128 v[56:59], v71 offset:0
    s_waitcnt lgkmcnt(3)
    v_mfma_f32_32x32x16_bf16 v[72:87], v[32:35], v[40:43], v[72:87]
    v_mfma_f32_32x32x16_bf16 v[88:103], v[36:39], v[40:43], v[88:103]
    s_waitcnt lgkmcnt(0)
    v_mfma_f32_32x32x16_bf16 v[72:87], v[48:51], v[56:59], v[72:87]
    v_mfma_f32_32x32x16_bf16 v[88:103], v[52:55], v[56:59], v[88:103]
    s_waitcnt vmcnt(12)
    s_barrier
    s_mov_b32 s37, 1536
    s_add_u32 m0, s35, 0
    s_nop 0
    buffer_load_dwordx4 v8, s[8:11], s37 offen lds
    s_add_u32 m0, s35, 1024
    s_nop 0
    buffer_load_dwordx4 v9, s[8:11], s37 offen lds
    s_add_u32 m0, s35, 2048
    s_nop 0
    buffer_load_dwordx4 v10, s[8:11], s37 offen lds
    s_add_u32 m0, s35, 3072
    s_nop 0
    buffer_load_dwordx4 v11, s[8:11], s37 offen lds
    s_add_u32 m0, s36, 0
    s_nop 0
    buffer_load_dwordx4 v12, s[12:15], s37 offen lds
    s_add_u32 m0, s36, 1024
    s_nop 0
    buffer_load_dwordx4 v13, s[12:15], s37 offen lds
    ds_read_b128 v[32:35], v64 offset:24576
    ds_read_b128 v[36:39], v64 offset:28672
    ds_read_b128 v[40:43], v68 offset:24576
    ds_read_b128 v[48:51], v65 offset:24576
    ds_read_b128 v[52:55], v65 offset:28672
    ds_read_b128 v[56:59], v69 offset:24576
    s_waitcnt lgkmcnt(3)
    v_mfma_f32_32x32x16_bf16 v[72:87], v[32:35], v[40:43], v[72:87]
    v_mfma_f32_32x32x16_bf16 v[88:103], v[36:39], v[40:43], v[88:103]
    ds_read_b128 v[32:35], v66 offset:24576
    ds_read_b128 v[36:39], v66 offset:28672
    ds_read_b128 v[40:43], v70 offset:24576
    s_waitcnt lgkmcnt(3)
    v_mfma_f32_32x32x16_bf16 v[72:87], v[48:51], v[56:59], v[72:87]
    v_mfma_f32_32x32x16_bf16 v[88:103], v[52:55], v[56:59], v[88:103]
    ds_read_b128 v[48:51], v67 offset:24576
    ds_read_b128 v[52:55], v67 offset:28672
    ds_read_b128 v[56:59], v71 offset:24576
    s_waitcnt lgkmcnt(3)
    v_mfma_f32_32x32x16_bf16 v[72:87], v[32:35], v[40:43], v[72:87]
    v_mfma_f32_32x32x16_bf16 v[88:103], v[36:39], v[40:43], v[88:103]
    s_waitcnt lgkmcnt(0)
    v_mfma_f32_32x32x16_bf16 v[72:87], v[48:51], v[56:59], v[72:87]
    v_mfma_f32_32x32x16_bf16 v[88:103], v[52:55], v[56:59], v[88:103]
    s_waitcnt vmcnt(12)
    s_barrier
    s_mov_b32 s37, 1664
    s_add_u32 m0, s35, 24576
    s_nop 0
    buffer_load_dwordx4 v8, s[8:11], s37 offen lds
    s_add_u32 m0, s35, 25600
    s_nop 0
    buffer_load_dwordx4 v9, s[8:11], s37 offen lds
    s_add_u32 m0, s35, 26624
    s_nop 0
    buffer_load_dwordx4 v10, s[8:11], s37 offen lds
    s_add_u32 m0, s35, 27648
    s_nop 0
    buffer_load_dwordx4 v11, s[8:11], s37 offen lds
    s_add_u32 m0, s36, 24576
    s_nop 0
    buffer_load_dwordx4 v12, s[12:15], s37 offen lds
    s_add_u32 m0, s36, 25600
    s_nop 0
    buffer_load_dwordx4 v13, s[12:15], s37 offen lds
    ds_read_b128 v[32:35], v104 offset:0
    ds_read_b128 v[36:39], v104 offset:4096
    ds_read_b128 v[40:43], v108 offset:0
    ds_read_b128 v[48:51], v105 offset:0
    ds_read_b128 v[52:55], v105 offset:4096
    ds_read_b128 v[56:59], v109 offset:0
    s_waitcnt lgkmcnt(3)
    v_mfma_f32_32x32x16_bf16 v[72:87], v[32:35], v[40:43], v[72:87]
    v_mfma_f32_32x32x16_bf16 v[88:103], v[36:39], v[40:43], v[88:103]
    ds_read_b128 v[32:35], v106 offset:0
    ds_read_b128 v[36:39], v106 offset:4096
    ds_read_b128 v[40:43], v110 offset:0
    s_waitcnt lgkmcnt(3)
    v_mfma_f32_32x32x16_bf16 v[72:87], v[48:51], v[56:59], v[72:87]
    v_mfma_f32_32x32x16_bf16 v[88:103], v[52:55], v[56:59], v[88:103]
    ds_read_b128 v[48:51], v107 offset:0
    ds_read_b128 v[52:55], v107 offset:4096
    ds_read_b128 v[56:59], v111 offset:0
    s_waitcnt lgkmcnt(3)
    v_mfma_f32_32x32x16_bf16 v[72:87], v[32:35], v[40:43], v[72:87]
    v_mfma_f32_32x32x16_bf16 v[88:103], v[36:39], v[40:43], v[88:103]
    s_waitcnt lgkmcnt(0)
    v_mfma_f32_32x32x16_bf16 v[72:87], v[48:51], v[56:59], v[72:87]
    v_mfma_f32_32x32x16_bf16 v[88:103], v[52:55], v[56:59], v[88:103]
    s_waitcnt vmcnt(12)
    s_barrier
    s_mov_b32 s37, 1792
    s_add_u32 m0, s35, 49152
    s_nop 0
    buffer_load_dwordx4 v8, s[8:11], s37 offen lds
    s_add_u32 m0, s35, 50176
    s_nop 0
    buffer_load_dwordx4 v9, s[8:11], s37 offen lds
    s_add_u32 m0, s35, 51200
    s_nop 0
    buffer_load_dwordx4 v10, s[8:11], s37 offen lds
    s_add_u32 m0, s35, 52224
    s_nop 0
    buffer_load_dwordx4 v11, s[8:11], s37 offen lds
    s_add_u32 m0, s36, 49152
    s_nop 0
    buffer_load_dwordx4 v12, s[12:15], s37 offen lds
    s_add_u32 m0, s36, 50176
    s_nop 0
    buffer_load_dwordx4 v13, s[12:15], s37 offen lds
    ds_read_b128 v[32:35], v104 offset:24576
    ds_read_b128 v[36:39], v104 offset:28672
    ds_read_b128 v[40:43], v108 offset:24576
    ds_read_b128 v[48:51], v105 offset:24576
    ds_read_b128 v[52:55], v105 offset:28672
    ds_read_b128 v[56:59], v109 offset:24576
    s_waitcnt lgkmcnt(3)
    v_mfma_f32_32x32x16_bf16 v[72:87], v[32:35], v[40:43], v[72:87]
    v_mfma_f32_32x32x16_bf16 v[88:103], v[36:39], v[40:43], v[88:103]
    ds_read_b128 v[32:35], v106 offset:24576
    ds_read_b128 v[36:39], v106 offset:28672
    ds_read_b128 v[40:43], v110 offset:24576
    s_waitcnt lgkmcnt(3)
    v_mfma_f32_32x32x16_bf16 v[72:87], v[48:51], v[56:59], v[72:87]
    v_mfma_f32_32x32x16_bf16 v[88:103], v[52:55], v[56:59], v[88:103]
    ds_read_b128 v[48:51], v107 offset:24576
    ds_read_b128 v[52:55], v107 offset:28672
    ds_read_b128 v[56:59], v111 offset:24576
    s_waitcnt lgkmcnt(3)
    v_mfma_f32_32x32x16_bf16 v[72:87], v[32:35], v[40:43], v[72:87]
    v_mfma_f32_32x32x16_bf16 v[88:103], v[36:39], v[40:43], v[88:103]
    s_waitcnt lgkmcnt(0)
    v_mfma_f32_32x32x16_bf16 v[72:87], v[48:51], v[56:59], v[72:87]
    v_mfma_f32_32x32x16_bf16 v[88:103], v[52:55], v[56:59], v[88:103]
    s_waitcnt vmcnt(12)
    s_barrier
    s_mov_b32 s37, 1920
    s_add_u32 m0, s35, 73728
    s_nop 0
    buffer_load_dwordx4 v8, s[8:11], s37 offen lds
    s_add_u32 m0, s35, 74752
    s_nop 0
    buffer_load_dwordx4 v9, s[8:11], s37 offen lds
    s_add_u32 m0, s35, 75776
    s_nop 0
    buffer_load_dwordx4 v10, s[8:11], s37 offen lds
    s_add_u32 m0, s35, 76800
    s_nop 0
    buffer_load_dwordx4 v11, s[8:11], s37 offen lds
    s_add_u32 m0, s36, 73728
    s_nop 0
    buffer_load_dwordx4 v12, s[12:15], s37 offen lds
    s_add_u32 m0, s36, 74752
    s_nop 0
    buffer_load_dwordx4 v13, s[12:15], s37 offen lds
    ds_read_b128 v[32:35], v64 offset:0
    ds_read_b128 v[36:39], v64 offset:4096
    ds_read_b128 v[40:43], v68 offset:0
    ds_read_b128 v[48:51], v65 offset:0
    ds_read_b128 v[52:55], v65 offset:4096
    ds_read_b128 v[56:59], v69 offset:0
    s_waitcnt lgkmcnt(3)
    v_mfma_f32_32x32x16_bf16 v[72:87], v[32:35], v[40:43], v[72:87]
    v_mfma_f32_32x32x16_bf16 v[88:103], v[36:39], v[40:43], v[88:103]
    ds_read_b128 v[32:35], v66 offset:0
    ds_read_b128 v[36:39], v66 offset:4096
    ds_read_b128 v[40:43], v70 offset:0
    s_waitcnt lgkmcnt(3)
    v_mfma_f32_32x32x16_bf16 v[72:87], v[48:51], v[56:59], v[72:87]
    v_mfma_f32_32x32x16_bf16 v[88:103], v[52:55], v[56:59], v[88:103]
    ds_read_b128 v[48:51], v67 offset:0
    ds_read_b128 v[52:55], v67 offset:4096
    ds_read_b128 v[56:59], v71 offset:0
    s_waitcnt lgkmcnt(3)
    v_mfma_f32_32x32x16_bf16 v[72:87], v[32:35], v[40:43], v[72:87]
    v_mfma_f32_32x32x16_bf16 v[88:103], v[36:39], v[40:43], v[88:103]
    s_waitcnt lgkmcnt(0)
    v_mfma_f32_32x32x16_bf16 v[72:87], v[48:51], v[56:59], v[72:87]
    v_mfma_f32_32x32x16_bf16 v[88:103], v[52:55], v[56:59], v[88:103]
    s_waitcnt vmcnt(12)
    s_barrier
    s_mov_b32 s37, 2048
    s_add_u32 m0, s35, 0
    s_nop 0
    buffer_load_dwordx4 v8, s[8:11], s37 offen lds
    s_add_u32 m0, s35, 1024
    s_nop 0
    buffer_load_dwordx4 v9, s[8:11], s37 offen lds
    s_add_u32 m0, s35, 2048
    s_nop 0
    buffer_load_dwordx4 v10, s[8:11], s37 offen lds
    s_add_u32 m0, s35, 3072
    s_nop 0
    buffer_load_dwordx4 v11, s[8:11], s37 offen lds
    s_add_u32 m0, s36, 0
    s_nop 0
    buffer_load_dwordx4 v12, s[12:15], s37 offen lds
    s_add_u32 m0, s36, 1024
    s_nop 0
    buffer_load_dwordx4 v13, s[12:15], s37 offen lds
    ds_read_b128 v[32:35], v64 offset:24576
    ds_read_b128 v[36:39], v64 offset:28672
    ds_read_b128 v[40:43], v68 offset:24576
    ds_read_b128 v[48:51], v65 offset:24576
    ds_read_b128 v[52:55], v65 offset:28672
    ds_read_b128 v[56:59], v69 offset:24576
    s_waitcnt lgkmcnt(3)
    v_mfma_f32_32x32x16_bf16 v[72:87], v[32:35], v[40:43], v[72:87]
    v_mfma_f32_32x32x16_bf16 v[88:103], v[36:39], v[40:43], v[88:103]
    ds_read_b128 v[32:35], v66 offset:24576
    ds_read_b128 v[36:39], v66 offset:28672
    ds_read_b128 v[40:43], v70 offset:24576
    s_waitcnt lgkmcnt(3)
    v_mfma_f32_32x32x16_bf16 v[72:87], v[48:51], v[56:59], v[72:87]
    v_mfma_f32_32x32x16_bf16 v[88:103], v[52:55], v[56:59], v[88:103]
    ds_read_b128 v[48:51], v67 offset:24576
    ds_read_b128 v[52:55], v67 offset:28672
    ds_read_b128 v[56:59], v71 offset:24576
    s_waitcnt lgkmcnt(3)
    v_mfma_f32_32x32x16_bf16 v[72:87], v[32:35], v[40:43], v[72:87]
    v_mfma_f32_32x32x16_bf16 v[88:103], v[36:39], v[40:43], v[88:103]
    s_waitcnt lgkmcnt(0)
    v_mfma_f32_32x32x16_bf16 v[72:87], v[48:51], v[56:59], v[72:87]
    v_mfma_f32_32x32x16_bf16 v[88:103], v[52:55], v[56:59], v[88:103]
    s_waitcnt vmcnt(12)
    s_barrier
    s_mov_b32 s37, 2176
    s_add_u32 m0, s35, 24576
    s_nop 0
    buffer_load_dwordx4 v8, s[8:11], s37 offen lds
    s_add_u32 m0, s35, 25600
    s_nop 0
    buffer_load_dwordx4 v9, s[8:11], s37 offen lds
    s_add_u32 m0, s35, 26624
    s_nop 0
    buffer_load_dwordx4 v10, s[8:11], s37 offen lds
    s_add_u32 m0, s35, 27648
    s_nop 0
    buffer_load_dwordx4 v11, s[8:11], s37 offen lds
    s_add_u32 m0, s36, 24576
    s_nop 0
    buffer_load_dwordx4 v12, s[12:15], s37 offen lds
    s_add_u32 m0, s36, 25600
    s_nop 0
    buffer_load_dwordx4 v13, s[12:15], s37 offen lds
    ds_read_b128 v[32:35], v104 offset:0
    ds_read_b128 v[36:39], v104 offset:4096
    ds_read_b128 v[40:43], v108 offset:0
    ds_read_b128 v[48:51], v105 offset:0
    ds_read_b128 v[52:55], v105 offset:4096
    ds_read_b128 v[56:59], v109 offset:0
    s_waitcnt lgkmcnt(3)
    v_mfma_f32_32x32x16_bf16 v[72:87], v[32:35], v[40:43], v[72:87]
    v_mfma_f32_32x32x16_bf16 v[88:103], v[36:39], v[40:43], v[88:103]
    ds_read_b128 v[32:35], v106 offset:0
    ds_read_b128 v[36:39], v106 offset:4096
    ds_read_b128 v[40:43], v110 offset:0
    s_waitcnt lgkmcnt(3)
    v_mfma_f32_32x32x16_bf16 v[72:87], v[48:51], v[56:59], v[72:87]
    v_mfma_f32_32x32x16_bf16 v[88:103], v[52:55], v[56:59], v[88:103]
    ds_read_b128 v[48:51], v107 offset:0
    ds_read_b128 v[52:55], v107 offset:4096
    ds_read_b128 v[56:59], v111 offset:0
    s_waitcnt lgkmcnt(3)
    v_mfma_f32_32x32x16_bf16 v[72:87], v[32:35], v[40:43], v[72:87]
    v_mfma_f32_32x32x16_bf16 v[88:103], v[36:39], v[40:43], v[88:103]
    s_waitcnt lgkmcnt(0)
    v_mfma_f32_32x32x16_bf16 v[72:87], v[48:51], v[56:59], v[72:87]
    v_mfma_f32_32x32x16_bf16 v[88:103], v[52:55], v[56:59], v[88:103]
    s_waitcnt vmcnt(12)
    s_barrier
    s_mov_b32 s37, 2304
    s_add_u32 m0, s35, 49152
    s_nop 0
    buffer_load_dwordx4 v8, s[8:11], s37 offen lds
    s_add_u32 m0, s35, 50176
    s_nop 0
    buffer_load_dwordx4 v9, s[8:11], s37 offen lds
    s_add_u32 m0, s35, 51200
    s_nop 0
    buffer_load_dwordx4 v10, s[8:11], s37 offen lds
    s_add_u32 m0, s35, 52224
    s_nop 0
    buffer_load_dwordx4 v11, s[8:11], s37 offen lds
    s_add_u32 m0, s36, 49152
    s_nop 0
    buffer_load_dwordx4 v12, s[12:15], s37 offen lds
    s_add_u32 m0, s36, 50176
    s_nop 0
    buffer_load_dwordx4 v13, s[12:15], s37 offen lds
    ds_read_b128 v[32:35], v104 offset:24576
    ds_read_b128 v[36:39], v104 offset:28672
    ds_read_b128 v[40:43], v108 offset:24576
    ds_read_b128 v[48:51], v105 offset:24576
    ds_read_b128 v[52:55], v105 offset:28672
    ds_read_b128 v[56:59], v109 offset:24576
    s_waitcnt lgkmcnt(3)
    v_mfma_f32_32x32x16_bf16 v[72:87], v[32:35], v[40:43], v[72:87]
    v_mfma_f32_32x32x16_bf16 v[88:103], v[36:39], v[40:43], v[88:103]
    ds_read_b128 v[32:35], v106 offset:24576
    ds_read_b128 v[36:39], v106 offset:28672
    ds_read_b128 v[40:43], v110 offset:24576
    s_waitcnt lgkmcnt(3)
    v_mfma_f32_32x32x16_bf16 v[72:87], v[48:51], v[56:59], v[72:87]
    v_mfma_f32_32x32x16_bf16 v[88:103], v[52:55], v[56:59], v[88:103]
    ds_read_b128 v[48:51], v107 offset:24576
    ds_read_b128 v[52:55], v107 offset:28672
    ds_read_b128 v[56:59], v111 offset:24576
    s_waitcnt lgkmcnt(3)
    v_mfma_f32_32x32x16_bf16 v[72:87], v[32:35], v[40:43], v[72:87]
    v_mfma_f32_32x32x16_bf16 v[88:103], v[36:39], v[40:43], v[88:103]
    s_waitcnt lgkmcnt(0)
    v_mfma_f32_32x32x16_bf16 v[72:87], v[48:51], v[56:59], v[72:87]
    v_mfma_f32_32x32x16_bf16 v[88:103], v[52:55], v[56:59], v[88:103]
    s_waitcnt vmcnt(12)
    s_barrier
    s_mov_b32 s37, 2432
    s_add_u32 m0, s35, 73728
    s_nop 0
    buffer_load_dwordx4 v8, s[8:11], s37 offen lds
    s_add_u32 m0, s35, 74752
    s_nop 0
    buffer_load_dwordx4 v9, s[8:11], s37 offen lds
    s_add_u32 m0, s35, 75776
    s_nop 0
    buffer_load_dwordx4 v10, s[8:11], s37 offen lds
    s_add_u32 m0, s35, 76800
    s_nop 0
    buffer_load_dwordx4 v11, s[8:11], s37 offen lds
    s_add_u32 m0, s36, 73728
    s_nop 0
    buffer_load_dwordx4 v12, s[12:15], s37 offen lds
    s_add_u32 m0, s36, 74752
    s_nop 0
    buffer_load_dwordx4 v13, s[12:15], s37 offen lds
    ds_read_b128 v[32:35], v64 offset:0
    ds_read_b128 v[36:39], v64 offset:4096
    ds_read_b128 v[40:43], v68 offset:0
    ds_read_b128 v[48:51], v65 offset:0
    ds_read_b128 v[52:55], v65 offset:4096
    ds_read_b128 v[56:59], v69 offset:0
    s_waitcnt lgkmcnt(3)
    v_mfma_f32_32x32x16_bf16 v[72:87], v[32:35], v[40:43], v[72:87]
    v_mfma_f32_32x32x16_bf16 v[88:103], v[36:39], v[40:43], v[88:103]
    ds_read_b128 v[32:35], v66 offset:0
    ds_read_b128 v[36:39], v66 offset:4096
    ds_read_b128 v[40:43], v70 offset:0
    s_waitcnt lgkmcnt(3)
    v_mfma_f32_32x32x16_bf16 v[72:87], v[48:51], v[56:59], v[72:87]
    v_mfma_f32_32x32x16_bf16 v[88:103], v[52:55], v[56:59], v[88:103]
    ds_read_b128 v[48:51], v67 offset:0
    ds_read_b128 v[52:55], v67 offset:4096
    ds_read_b128 v[56:59], v71 offset:0
    s_waitcnt lgkmcnt(3)
    v_mfma_f32_32x32x16_bf16 v[72:87], v[32:35], v[40:43], v[72:87]
    v_mfma_f32_32x32x16_bf16 v[88:103], v[36:39], v[40:43], v[88:103]
    s_waitcnt lgkmcnt(0)
    v_mfma_f32_32x32x16_bf16 v[72:87], v[48:51], v[56:59], v[72:87]
    v_mfma_f32_32x32x16_bf16 v[88:103], v[52:55], v[56:59], v[88:103]
    s_waitcnt vmcnt(12)
    s_barrier
    s_mov_b32 s37, 2560
    s_add_u32 m0, s35, 0
    s_nop 0
    buffer_load_dwordx4 v8, s[8:11], s37 offen lds
    s_add_u32 m0, s35, 1024
    s_nop 0
    buffer_load_dwordx4 v9, s[8:11], s37 offen lds
    s_add_u32 m0, s35, 2048
    s_nop 0
    buffer_load_dwordx4 v10, s[8:11], s37 offen lds
    s_add_u32 m0, s35, 3072
    s_nop 0
    buffer_load_dwordx4 v11, s[8:11], s37 offen lds
    s_add_u32 m0, s36, 0
    s_nop 0
    buffer_load_dwordx4 v12, s[12:15], s37 offen lds
    s_add_u32 m0, s36, 1024
    s_nop 0
    buffer_load_dwordx4 v13, s[12:15], s37 offen lds
    ds_read_b128 v[32:35], v64 offset:24576
    ds_read_b128 v[36:39], v64 offset:28672
    ds_read_b128 v[40:43], v68 offset:24576
    ds_read_b128 v[48:51], v65 offset:24576
    ds_read_b128 v[52:55], v65 offset:28672
    ds_read_b128 v[56:59], v69 offset:24576
    s_waitcnt lgkmcnt(3)
    v_mfma_f32_32x32x16_bf16 v[72:87], v[32:35], v[40:43], v[72:87]
    v_mfma_f32_32x32x16_bf16 v[88:103], v[36:39], v[40:43], v[88:103]
    ds_read_b128 v[32:35], v66 offset:24576
    ds_read_b128 v[36:39], v66 offset:28672
    ds_read_b128 v[40:43], v70 offset:24576
    s_waitcnt lgkmcnt(3)
    v_mfma_f32_32x32x16_bf16 v[72:87], v[48:51], v[56:59], v[72:87]
    v_mfma_f32_32x32x16_bf16 v[88:103], v[52:55], v[56:59], v[88:103]
    ds_read_b128 v[48:51], v67 offset:24576
    ds_read_b128 v[52:55], v67 offset:28672
    ds_read_b128 v[56:59], v71 offset:24576
    s_waitcnt lgkmcnt(3)
    v_mfma_f32_32x32x16_bf16 v[72:87], v[32:35], v[40:43], v[72:87]
    v_mfma_f32_32x32x16_bf16 v[88:103], v[36:39], v[40:43], v[88:103]
    s_waitcnt lgkmcnt(0)
    v_mfma_f32_32x32x16_bf16 v[72:87], v[48:51], v[56:59], v[72:87]
    v_mfma_f32_32x32x16_bf16 v[88:103], v[52:55], v[56:59], v[88:103]
    s_waitcnt vmcnt(12)
    s_barrier
    s_mov_b32 s37, 2688
    s_add_u32 m0, s35, 24576
    s_nop 0
    buffer_load_dwordx4 v8, s[8:11], s37 offen lds
    s_add_u32 m0, s35, 25600
    s_nop 0
    buffer_load_dwordx4 v9, s[8:11], s37 offen lds
    s_add_u32 m0, s35, 26624
    s_nop 0
    buffer_load_dwordx4 v10, s[8:11], s37 offen lds
    s_add_u32 m0, s35, 27648
    s_nop 0
    buffer_load_dwordx4 v11, s[8:11], s37 offen lds
    s_add_u32 m0, s36, 24576
    s_nop 0
    buffer_load_dwordx4 v12, s[12:15], s37 offen lds
    s_add_u32 m0, s36, 25600
    s_nop 0
    buffer_load_dwordx4 v13, s[12:15], s37 offen lds
    ds_read_b128 v[32:35], v104 offset:0
    ds_read_b128 v[36:39], v104 offset:4096
    ds_read_b128 v[40:43], v108 offset:0
    ds_read_b128 v[48:51], v105 offset:0
    ds_read_b128 v[52:55], v105 offset:4096
    ds_read_b128 v[56:59], v109 offset:0
    s_waitcnt lgkmcnt(3)
    v_mfma_f32_32x32x16_bf16 v[72:87], v[32:35], v[40:43], v[72:87]
    v_mfma_f32_32x32x16_bf16 v[88:103], v[36:39], v[40:43], v[88:103]
    ds_read_b128 v[32:35], v106 offset:0
    ds_read_b128 v[36:39], v106 offset:4096
    ds_read_b128 v[40:43], v110 offset:0
    s_waitcnt lgkmcnt(3)
    v_mfma_f32_32x32x16_bf16 v[72:87], v[48:51], v[56:59], v[72:87]
    v_mfma_f32_32x32x16_bf16 v[88:103], v[52:55], v[56:59], v[88:103]
    ds_read_b128 v[48:51], v107 offset:0
    ds_read_b128 v[52:55], v107 offset:4096
    ds_read_b128 v[56:59], v111 offset:0
    s_waitcnt lgkmcnt(3)
    v_mfma_f32_32x32x16_bf16 v[72:87], v[32:35], v[40:43], v[72:87]
    v_mfma_f32_32x32x16_bf16 v[88:103], v[36:39], v[40:43], v[88:103]
    s_waitcnt lgkmcnt(0)
    v_mfma_f32_32x32x16_bf16 v[72:87], v[48:51], v[56:59], v[72:87]
    v_mfma_f32_32x32x16_bf16 v[88:103], v[52:55], v[56:59], v[88:103]
    s_waitcnt vmcnt(12)
    s_barrier
    s_mov_b32 s37, 2816
    s_add_u32 m0, s35, 49152
    s_nop 0
    buffer_load_dwordx4 v8, s[8:11], s37 offen lds
    s_add_u32 m0, s35, 50176
    s_nop 0
    buffer_load_dwordx4 v9, s[8:11], s37 offen lds
    s_add_u32 m0, s35, 51200
    s_nop 0
    buffer_load_dwordx4 v10, s[8:11], s37 offen lds
    s_add_u32 m0, s35, 52224
    s_nop 0
    buffer_load_dwordx4 v11, s[8:11], s37 offen lds
    s_add_u32 m0, s36, 49152
    s_nop 0
    buffer_load_dwordx4 v12, s[12:15], s37 offen lds
    s_add_u32 m0, s36, 50176
    s_nop 0
    buffer_load_dwordx4 v13, s[12:15], s37 offen lds
    ds_read_b128 v[32:35], v104 offset:24576
    ds_read_b128 v[36:39], v104 offset:28672
    ds_read_b128 v[40:43], v108 offset:24576
    ds_read_b128 v[48:51], v105 offset:24576
    ds_read_b128 v[52:55], v105 offset:28672
    ds_read_b128 v[56:59], v109 offset:24576
    s_waitcnt lgkmcnt(3)
    v_mfma_f32_32x32x16_bf16 v[72:87], v[32:35], v[40:43], v[72:87]
    v_mfma_f32_32x32x16_bf16 v[88:103], v[36:39], v[40:43], v[88:103]
    ds_read_b128 v[32:35], v106 offset:24576
    ds_read_b128 v[36:39], v106 offset:28672
    ds_read_b128 v[40:43], v110 offset:24576
    s_waitcnt lgkmcnt(3)
    v_mfma_f32_32x32x16_bf16 v[72:87], v[48:51], v[56:59], v[72:87]
    v_mfma_f32_32x32x16_bf16 v[88:103], v[52:55], v[56:59], v[88:103]
    ds_read_b128 v[48:51], v107 offset:24576
    ds_read_b128 v[52:55], v107 offset:28672
    ds_read_b128 v[56:59], v111 offset:24576
    s_waitcnt lgkmcnt(3)
    v_mfma_f32_32x32x16_bf16 v[72:87], v[32:35], v[40:43], v[72:87]
    v_mfma_f32_32x32x16_bf16 v[88:103], v[36:39], v[40:43], v[88:103]
    s_waitcnt lgkmcnt(0)
    v_mfma_f32_32x32x16_bf16 v[72:87], v[48:51], v[56:59], v[72:87]
    v_mfma_f32_32x32x16_bf16 v[88:103], v[52:55], v[56:59], v[88:103]
    s_waitcnt vmcnt(12)
    s_barrier
    s_mov_b32 s37, 2944
    s_add_u32 m0, s35, 73728
    s_nop 0
    buffer_load_dwordx4 v8, s[8:11], s37 offen lds
    s_add_u32 m0, s35, 74752
    s_nop 0
    buffer_load_dwordx4 v9, s[8:11], s37 offen lds
    s_add_u32 m0, s35, 75776
    s_nop 0
    buffer_load_dwordx4 v10, s[8:11], s37 offen lds
    s_add_u32 m0, s35, 76800
    s_nop 0
    buffer_load_dwordx4 v11, s[8:11], s37 offen lds
    s_add_u32 m0, s36, 73728
    s_nop 0
    buffer_load_dwordx4 v12, s[12:15], s37 offen lds
    s_add_u32 m0, s36, 74752
    s_nop 0
    buffer_load_dwordx4 v13, s[12:15], s37 offen lds
    ds_read_b128 v[32:35], v64 offset:0
    ds_read_b128 v[36:39], v64 offset:4096
    ds_read_b128 v[40:43], v68 offset:0
    ds_read_b128 v[48:51], v65 offset:0
    ds_read_b128 v[52:55], v65 offset:4096
    ds_read_b128 v[56:59], v69 offset:0
    s_waitcnt lgkmcnt(3)
    v_mfma_f32_32x32x16_bf16 v[72:87], v[32:35], v[40:43], v[72:87]
    v_mfma_f32_32x32x16_bf16 v[88:103], v[36:39], v[40:43], v[88:103]
    ds_read_b128 v[32:35], v66 offset:0
    ds_read_b128 v[36:39], v66 offset:4096
    ds_read_b128 v[40:43], v70 offset:0
    s_waitcnt lgkmcnt(3)
    v_mfma_f32_32x32x16_bf16 v[72:87], v[48:51], v[56:59], v[72:87]
    v_mfma_f32_32x32x16_bf16 v[88:103], v[52:55], v[56:59], v[88:103]
    ds_read_b128 v[48:51], v67 offset:0
    ds_read_b128 v[52:55], v67 offset:4096
    ds_read_b128 v[56:59], v71 offset:0
    s_waitcnt lgkmcnt(3)
    v_mfma_f32_32x32x16_bf16 v[72:87], v[32:35], v[40:43], v[72:87]
    v_mfma_f32_32x32x16_bf16 v[88:103], v[36:39], v[40:43], v[88:103]
    s_waitcnt lgkmcnt(0)
    v_mfma_f32_32x32x16_bf16 v[72:87], v[48:51], v[56:59], v[72:87]
    v_mfma_f32_32x32x16_bf16 v[88:103], v[52:55], v[56:59], v[88:103]
    s_waitcnt vmcnt(12)
    s_barrier
    s_mov_b32 s37, 3072
    s_add_u32 m0, s35, 0
    s_nop 0
    buffer_load_dwordx4 v8, s[8:11], s37 offen lds
    s_add_u32 m0, s35, 1024
    s_nop 0
    buffer_load_dwordx4 v9, s[8:11], s37 offen lds
    s_add_u32 m0, s35, 2048
    s_nop 0
    buffer_load_dwordx4 v10, s[8:11], s37 offen lds
    s_add_u32 m0, s35, 3072
    s_nop 0
    buffer_load_dwordx4 v11, s[8:11], s37 offen lds
    s_add_u32 m0, s36, 0
    s_nop 0
    buffer_load_dwordx4 v12, s[12:15], s37 offen lds
    s_add_u32 m0, s36, 1024
    s_nop 0
    buffer_load_dwordx4 v13, s[12:15], s37 offen lds
    ds_read_b128 v[32:35], v64 offset:24576
    ds_read_b128 v[36:39], v64 offset:28672
    ds_read_b128 v[40:43], v68 offset:24576
    ds_read_b128 v[48:51], v65 offset:24576
    ds_read_b128 v[52:55], v65 offset:28672
    ds_read_b128 v[56:59], v69 offset:24576
    s_waitcnt lgkmcnt(3)
    v_mfma_f32_32x32x16_bf16 v[72:87], v[32:35], v[40:43], v[72:87]
    v_mfma_f32_32x32x16_bf16 v[88:103], v[36:39], v[40:43], v[88:103]
    ds_read_b128 v[32:35], v66 offset:24576
    ds_read_b128 v[36:39], v66 offset:28672
    ds_read_b128 v[40:43], v70 offset:24576
    s_waitcnt lgkmcnt(3)
    v_mfma_f32_32x32x16_bf16 v[72:87], v[48:51], v[56:59], v[72:87]
    v_mfma_f32_32x32x16_bf16 v[88:103], v[52:55], v[56:59], v[88:103]
    ds_read_b128 v[48:51], v67 offset:24576
    ds_read_b128 v[52:55], v67 offset:28672
    ds_read_b128 v[56:59], v71 offset:24576
    s_waitcnt lgkmcnt(3)
    v_mfma_f32_32x32x16_bf16 v[72:87], v[32:35], v[40:43], v[72:87]
    v_mfma_f32_32x32x16_bf16 v[88:103], v[36:39], v[40:43], v[88:103]
    s_waitcnt lgkmcnt(0)
    v_mfma_f32_32x32x16_bf16 v[72:87], v[48:51], v[56:59], v[72:87]
    v_mfma_f32_32x32x16_bf16 v[88:103], v[52:55], v[56:59], v[88:103]
    s_waitcnt vmcnt(12)
    s_barrier
    s_mov_b32 s37, 3200
    s_add_u32 m0, s35, 24576
    s_nop 0
    buffer_load_dwordx4 v8, s[8:11], s37 offen lds
    s_add_u32 m0, s35, 25600
    s_nop 0
    buffer_load_dwordx4 v9, s[8:11], s37 offen lds
    s_add_u32 m0, s35, 26624
    s_nop 0
    buffer_load_dwordx4 v10, s[8:11], s37 offen lds
    s_add_u32 m0, s35, 27648
    s_nop 0
    buffer_load_dwordx4 v11, s[8:11], s37 offen lds
    s_add_u32 m0, s36, 24576
    s_nop 0
    buffer_load_dwordx4 v12, s[12:15], s37 offen lds
    s_add_u32 m0, s36, 25600
    s_nop 0
    buffer_load_dwordx4 v13, s[12:15], s37 offen lds
    ds_read_b128 v[32:35], v104 offset:0
    ds_read_b128 v[36:39], v104 offset:4096
    ds_read_b128 v[40:43], v108 offset:0
    ds_read_b128 v[48:51], v105 offset:0
    ds_read_b128 v[52:55], v105 offset:4096
    ds_read_b128 v[56:59], v109 offset:0
    s_waitcnt lgkmcnt(3)
    v_mfma_f32_32x32x16_bf16 v[72:87], v[32:35], v[40:43], v[72:87]
    v_mfma_f32_32x32x16_bf16 v[88:103], v[36:39], v[40:43], v[88:103]
    ds_read_b128 v[32:35], v106 offset:0
    ds_read_b128 v[36:39], v106 offset:4096
    ds_read_b128 v[40:43], v110 offset:0
    s_waitcnt lgkmcnt(3)
    v_mfma_f32_32x32x16_bf16 v[72:87], v[48:51], v[56:59], v[72:87]
    v_mfma_f32_32x32x16_bf16 v[88:103], v[52:55], v[56:59], v[88:103]
    ds_read_b128 v[48:51], v107 offset:0
    ds_read_b128 v[52:55], v107 offset:4096
    ds_read_b128 v[56:59], v111 offset:0
    s_waitcnt lgkmcnt(3)
    v_mfma_f32_32x32x16_bf16 v[72:87], v[32:35], v[40:43], v[72:87]
    v_mfma_f32_32x32x16_bf16 v[88:103], v[36:39], v[40:43], v[88:103]
    s_waitcnt lgkmcnt(0)
    v_mfma_f32_32x32x16_bf16 v[72:87], v[48:51], v[56:59], v[72:87]
    v_mfma_f32_32x32x16_bf16 v[88:103], v[52:55], v[56:59], v[88:103]
    s_waitcnt vmcnt(12)
    s_barrier
    s_mov_b32 s37, 3328
    s_add_u32 m0, s35, 49152
    s_nop 0
    buffer_load_dwordx4 v8, s[8:11], s37 offen lds
    s_add_u32 m0, s35, 50176
    s_nop 0
    buffer_load_dwordx4 v9, s[8:11], s37 offen lds
    s_add_u32 m0, s35, 51200
    s_nop 0
    buffer_load_dwordx4 v10, s[8:11], s37 offen lds
    s_add_u32 m0, s35, 52224
    s_nop 0
    buffer_load_dwordx4 v11, s[8:11], s37 offen lds
    s_add_u32 m0, s36, 49152
    s_nop 0
    buffer_load_dwordx4 v12, s[12:15], s37 offen lds
    s_add_u32 m0, s36, 50176
    s_nop 0
    buffer_load_dwordx4 v13, s[12:15], s37 offen lds
    ds_read_b128 v[32:35], v104 offset:24576
    ds_read_b128 v[36:39], v104 offset:28672
    ds_read_b128 v[40:43], v108 offset:24576
    ds_read_b128 v[48:51], v105 offset:24576
    ds_read_b128 v[52:55], v105 offset:28672
    ds_read_b128 v[56:59], v109 offset:24576
    s_waitcnt lgkmcnt(3)
    v_mfma_f32_32x32x16_bf16 v[72:87], v[32:35], v[40:43], v[72:87]
    v_mfma_f32_32x32x16_bf16 v[88:103], v[36:39], v[40:43], v[88:103]
    ds_read_b128 v[32:35], v106 offset:24576
    ds_read_b128 v[36:39], v106 offset:28672
    ds_read_b128 v[40:43], v110 offset:24576
    s_waitcnt lgkmcnt(3)
    v_mfma_f32_32x32x16_bf16 v[72:87], v[48:51], v[56:59], v[72:87]
    v_mfma_f32_32x32x16_bf16 v[88:103], v[52:55], v[56:59], v[88:103]
    ds_read_b128 v[48:51], v107 offset:24576
    ds_read_b128 v[52:55], v107 offset:28672
    ds_read_b128 v[56:59], v111 offset:24576
    s_waitcnt lgkmcnt(3)
    v_mfma_f32_32x32x16_bf16 v[72:87], v[32:35], v[40:43], v[72:87]
    v_mfma_f32_32x32x16_bf16 v[88:103], v[36:39], v[40:43], v[88:103]
    s_waitcnt lgkmcnt(0)
    v_mfma_f32_32x32x16_bf16 v[72:87], v[48:51], v[56:59], v[72:87]
    v_mfma_f32_32x32x16_bf16 v[88:103], v[52:55], v[56:59], v[88:103]
    s_waitcnt vmcnt(12)
    s_barrier
    ds_read_b128 v[32:35], v64 offset:0
    ds_read_b128 v[36:39], v64 offset:4096
    ds_read_b128 v[40:43], v68 offset:0
    ds_read_b128 v[48:51], v65 offset:0
    ds_read_b128 v[52:55], v65 offset:4096
    ds_read_b128 v[56:59], v69 offset:0
    s_waitcnt lgkmcnt(3)
    v_mfma_f32_32x32x16_bf16 v[72:87], v[32:35], v[40:43], v[72:87]
    v_mfma_f32_32x32x16_bf16 v[88:103], v[36:39], v[40:43], v[88:103]
    ds_read_b128 v[32:35], v66 offset:0
    ds_read_b128 v[36:39], v66 offset:4096
    ds_read_b128 v[40:43], v70 offset:0
    s_waitcnt lgkmcnt(3)
    v_mfma_f32_32x32x16_bf16 v[72:87], v[48:51], v[56:59], v[72:87]
    v_mfma_f32_32x32x16_bf16 v[88:103], v[52:55], v[56:59], v[88:103]
    ds_read_b128 v[48:51], v67 offset:0
    ds_read_b128 v[52:55], v67 offset:4096
    ds_read_b128 v[56:59], v71 offset:0
    s_waitcnt lgkmcnt(3)
    v_mfma_f32_32x32x16_bf16 v[72:87], v[32:35], v[40:43], v[72:87]
    v_mfma_f32_32x32x16_bf16 v[88:103], v[36:39], v[40:43], v[88:103]
    s_waitcnt lgkmcnt(0)
    v_mfma_f32_32x32x16_bf16 v[72:87], v[48:51], v[56:59], v[72:87]
    v_mfma_f32_32x32x16_bf16 v[88:103], v[52:55], v[56:59], v[88:103]
    s_waitcnt vmcnt(6)
    s_barrier
    ds_read_b128 v[32:35], v64 offset:24576
    ds_read_b128 v[36:39], v64 offset:28672
    ds_read_b128 v[40:43], v68 offset:24576
    ds_read_b128 v[48:51], v65 offset:24576
    ds_read_b128 v[52:55], v65 offset:28672
    ds_read_b128 v[56:59], v69 offset:24576
    s_waitcnt lgkmcnt(3)
    v_mfma_f32_32x32x16_bf16 v[72:87], v[32:35], v[40:43], v[72:87]
    v_mfma_f32_32x32x16_bf16 v[88:103], v[36:39], v[40:43], v[88:103]
    ds_read_b128 v[32:35], v66 offset:24576
    ds_read_b128 v[36:39], v66 offset:28672
    ds_read_b128 v[40:43], v70 offset:24576
    s_waitcnt lgkmcnt(3)
    v_mfma_f32_32x32x16_bf16 v[72:87], v[48:51], v[56:59], v[72:87]
    v_mfma_f32_32x32x16_bf16 v[88:103], v[52:55], v[56:59], v[88:103]
    ds_read_b128 v[48:51], v67 offset:24576
    ds_read_b128 v[52:55], v67 offset:28672
    ds_read_b128 v[56:59], v71 offset:24576
    s_waitcnt lgkmcnt(3)
    v_mfma_f32_32x32x16_bf16 v[72:87], v[32:35], v[40:43], v[72:87]
    v_mfma_f32_32x32x16_bf16 v[88:103], v[36:39], v[40:43], v[88:103]
    s_waitcnt lgkmcnt(0)
    v_mfma_f32_32x32x16_bf16 v[72:87], v[48:51], v[56:59], v[72:87]
    v_mfma_f32_32x32x16_bf16 v[88:103], v[52:55], v[56:59], v[88:103]
    s_waitcnt vmcnt(0)
    s_barrier
    ds_read_b128 v[32:35], v104 offset:0
    ds_read_b128 v[36:39], v104 offset:4096
    ds_read_b128 v[40:43], v108 offset:0
    ds_read_b128 v[48:51], v105 offset:0
    ds_read_b128 v[52:55], v105 offset:4096
    ds_read_b128 v[56:59], v109 offset:0
    s_waitcnt lgkmcnt(3)
    v_mfma_f32_32x32x16_bf16 v[72:87], v[32:35], v[40:43], v[72:87]
    v_mfma_f32_32x32x16_bf16 v[88:103], v[36:39], v[40:43], v[88:103]
    ds_read_b128 v[32:35], v106 offset:0
    ds_read_b128 v[36:39], v106 offset:4096
    ds_read_b128 v[40:43], v110 offset:0
    s_waitcnt lgkmcnt(3)
    v_mfma_f32_32x32x16_bf16 v[72:87], v[48:51], v[56:59], v[72:87]
    v_mfma_f32_32x32x16_bf16 v[88:103], v[52:55], v[56:59], v[88:103]
    ds_read_b128 v[48:51], v107 offset:0
    ds_read_b128 v[52:55], v107 offset:4096
    ds_read_b128 v[56:59], v111 offset:0
    s_waitcnt lgkmcnt(3)
    v_mfma_f32_32x32x16_bf16 v[72:87], v[32:35], v[40:43], v[72:87]
    v_mfma_f32_32x32x16_bf16 v[88:103], v[36:39], v[40:43], v[88:103]
    s_waitcnt lgkmcnt(0)
    v_mfma_f32_32x32x16_bf16 v[72:87], v[48:51], v[56:59], v[72:87]
    v_mfma_f32_32x32x16_bf16 v[88:103], v[52:55], v[56:59], v[88:103]
    s_nop 7
    s_nop 7
    s_mov_b32 s16, s42
    s_mov_b32 s17, s43
    s_mov_b32 s18, 2621440
    s_mov_b32 s19, 0x00020000
    s_mov_b32 s20, s40
    s_mov_b32 s21, s41
    s_mov_b32 s22, 2621440
    s_mov_b32 s23, 0x00020000
    s_add_u32 s24, s40, 19005440
    s_addc_u32 s25, s41, 0
    s_mov_b32 s26, 2621440
    s_mov_b32 s27, 0x00020000
    s_mov_b32 s28, s44
    s_mov_b32 s29, s45
    s_mov_b32 s30, 2621440
    s_mov_b32 s31, 0x00020000
    v_and_b32 v3, 31, v1
    v_lshrrev_b32 v4, 5, v1
    v_and_b32 v7, 1, v2
    v_lshrrev_b32 v6, 1, v2
    v_mul_u32_u24 v5, 32, v7
    v_add_u32 v5, v5, v3
    v_add_u32 v5, s7, v5
    v_mul_u32_u24 v6, 64, v6
    v_add_u32 v6, s6, v6
    v_lshlrev_b32 v4, 2, v4
    v_add_u32 v6, v6, v4
    v_mul_u32_u24 v8, 1280, v5
    v_lshlrev_b32 v9, 1, v6
    v_add_u32 v8, v8, v9
    v_lshlrev_b32 v9, 12, v6
    v_lshlrev_b32 v10, 1, v5
    v_add_u32 v9, v9, v10
    v_add_u32 v20, 0, v9
    v_add_u32 v21, 4096, v9
    v_add_u32 v22, 8192, v9
    v_add_u32 v23, 12288, v9
    buffer_load_dwordx2 v[168:169], v8, s[16:19], 0 offen offset:0
    buffer_load_dwordx2 v[170:171], v8, s[20:23], 0 offen offset:0
    s_mov_b32 s3, 0
    buffer_load_ushort v172, v20, s[24:27], s3 offen
    buffer_load_ushort v173, v21, s[24:27], s3 offen
    buffer_load_ushort v174, v22, s[24:27], s3 offen
    buffer_load_ushort v175, v23, s[24:27], s3 offen
    buffer_load_dwordx2 v[176:177], v8, s[16:19], 0 offen offset:16
    buffer_load_dwordx2 v[178:179], v8, s[20:23], 0 offen offset:16
    s_mov_b32 s3, 32768
    buffer_load_ushort v180, v20, s[24:27], s3 offen
    buffer_load_ushort v181, v21, s[24:27], s3 offen
    buffer_load_ushort v182, v22, s[24:27], s3 offen
    buffer_load_ushort v183, v23, s[24:27], s3 offen
    buffer_load_dwordx2 v[184:185], v8, s[16:19], 0 offen offset:32
    buffer_load_dwordx2 v[186:187], v8, s[20:23], 0 offen offset:32
    s_mov_b32 s3, 65536
    buffer_load_ushort v188, v20, s[24:27], s3 offen
    buffer_load_ushort v189, v21, s[24:27], s3 offen
    buffer_load_ushort v190, v22, s[24:27], s3 offen
    buffer_load_ushort v191, v23, s[24:27], s3 offen
    buffer_load_dwordx2 v[192:193], v8, s[16:19], 0 offen offset:48
    buffer_load_dwordx2 v[194:195], v8, s[20:23], 0 offen offset:48
    s_mov_b32 s3, 98304
    buffer_load_ushort v196, v20, s[24:27], s3 offen
    buffer_load_ushort v197, v21, s[24:27], s3 offen
    buffer_load_ushort v198, v22, s[24:27], s3 offen
    buffer_load_ushort v199, v23, s[24:27], s3 offen
    buffer_load_dwordx2 v[200:201], v8, s[16:19], 0 offen offset:64
    buffer_load_dwordx2 v[202:203], v8, s[20:23], 0 offen offset:64
    s_mov_b32 s3, 131072
    buffer_load_ushort v204, v20, s[24:27], s3 offen
    buffer_load_ushort v205, v21, s[24:27], s3 offen
    buffer_load_ushort v206, v22, s[24:27], s3 offen
    buffer_load_ushort v207, v23, s[24:27], s3 offen
    buffer_load_dwordx2 v[208:209], v8, s[16:19], 0 offen offset:80
    buffer_load_dwordx2 v[210:211], v8, s[20:23], 0 offen offset:80
    s_mov_b32 s3, 163840
    buffer_load_ushort v212, v20, s[24:27], s3 offen
    buffer_load_ushort v213, v21, s[24:27], s3 offen
    buffer_load_ushort v214, v22, s[24:27], s3 offen
    buffer_load_ushort v215, v23, s[24:27], s3 offen
    buffer_load_dwordx2 v[216:217], v8, s[16:19], 0 offen offset:96
    buffer_load_dwordx2 v[218:219], v8, s[20:23], 0 offen offset:96
    s_mov_b32 s3, 196608
    buffer_load_ushort v220, v20, s[24:27], s3 offen
    buffer_load_ushort v221, v21, s[24:27], s3 offen
    buffer_load_ushort v222, v22, s[24:27], s3 offen
    buffer_load_ushort v223, v23, s[24:27], s3 offen
    buffer_load_dwordx2 v[224:225], v8, s[16:19], 0 offen offset:112
    buffer_load_dwordx2 v[226:227], v8, s[20:23], 0 offen offset:112
    s_mov_b32 s3, 229376
    buffer_load_ushort v228, v20, s[24:27], s3 offen
    buffer_load_ushort v229, v21, s[24:27], s3 offen
    buffer_load_ushort v230, v22, s[24:27], s3 offen
    buffer_load_ushort v231, v23, s[24:27], s3 offen
    s_waitcnt vmcnt(42)
    v_lshlrev_b32 v24, 16, v168
    v_lshlrev_b32 v25, 16, v170
    v_lshlrev_b32 v26, 16, v172
    v_mul_f32 v25, v25, v26
    v_cvt_pk_bf16_f32 v25, v25, v25
    v_lshlrev_b32 v25, 16, v25
    v_add_f32 v24, v24, v25
    v_cvt_pk_bf16_f32 v24, v24, v24
    v_lshlrev_b32 v24, 16, v24
    v_cvt_pk_bf16_f32 v72, v72, v72
    v_lshlrev_b32 v72, 16, v72
    v_add_f32 v28, v24, v72
    v_and_b32 v24, 0xffff0000, v168
    v_and_b32 v25, 0xffff0000, v170
    v_lshlrev_b32 v26, 16, v173
    v_mul_f32 v25, v25, v26
    v_cvt_pk_bf16_f32 v25, v25, v25
    v_lshlrev_b32 v25, 16, v25
    v_add_f32 v24, v24, v25
    v_cvt_pk_bf16_f32 v24, v24, v24
    v_lshlrev_b32 v24, 16, v24
    v_cvt_pk_bf16_f32 v73, v73, v73
    v_lshlrev_b32 v73, 16, v73
    v_add_f32 v29, v24, v73
    v_lshlrev_b32 v24, 16, v169
    v_lshlrev_b32 v25, 16, v171
    v_lshlrev_b32 v26, 16, v174
    v_mul_f32 v25, v25, v26
    v_cvt_pk_bf16_f32 v25, v25, v25
    v_lshlrev_b32 v25, 16, v25
    v_add_f32 v24, v24, v25
    v_cvt_pk_bf16_f32 v24, v24, v24
    v_lshlrev_b32 v24, 16, v24
    v_cvt_pk_bf16_f32 v74, v74, v74
    v_lshlrev_b32 v74, 16, v74
    v_add_f32 v30, v24, v74
    v_and_b32 v24, 0xffff0000, v169
    v_and_b32 v25, 0xffff0000, v171
    v_lshlrev_b32 v26, 16, v175
    v_mul_f32 v25, v25, v26
    v_cvt_pk_bf16_f32 v25, v25, v25
    v_lshlrev_b32 v25, 16, v25
    v_add_f32 v24, v24, v25
    v_cvt_pk_bf16_f32 v24, v24, v24
    v_lshlrev_b32 v24, 16, v24
    v_cvt_pk_bf16_f32 v75, v75, v75
    v_lshlrev_b32 v75, 16, v75
    v_add_f32 v31, v24, v75
    v_cvt_pk_bf16_f32 v26, v28, v29
    v_cvt_pk_bf16_f32 v27, v30, v31
    buffer_store_dwordx2 v[26:27], v8, s[28:31], 0 offen offset:0
    s_waitcnt vmcnt(37)
    v_lshlrev_b32 v24, 16, v176
    v_lshlrev_b32 v25, 16, v178
    v_lshlrev_b32 v26, 16, v180
    v_mul_f32 v25, v25, v26
    v_cvt_pk_bf16_f32 v25, v25, v25
    v_lshlrev_b32 v25, 16, v25
    v_add_f32 v24, v24, v25
    v_cvt_pk_bf16_f32 v24, v24, v24
    v_lshlrev_b32 v24, 16, v24
    v_cvt_pk_bf16_f32 v76, v76, v76
    v_lshlrev_b32 v76, 16, v76
    v_add_f32 v28, v24, v76
    v_and_b32 v24, 0xffff0000, v176
    v_and_b32 v25, 0xffff0000, v178
    v_lshlrev_b32 v26, 16, v181
    v_mul_f32 v25, v25, v26
    v_cvt_pk_bf16_f32 v25, v25, v25
    v_lshlrev_b32 v25, 16, v25
    v_add_f32 v24, v24, v25
    v_cvt_pk_bf16_f32 v24, v24, v24
    v_lshlrev_b32 v24, 16, v24
    v_cvt_pk_bf16_f32 v77, v77, v77
    v_lshlrev_b32 v77, 16, v77
    v_add_f32 v29, v24, v77
    v_lshlrev_b32 v24, 16, v177
    v_lshlrev_b32 v25, 16, v179
    v_lshlrev_b32 v26, 16, v182
    v_mul_f32 v25, v25, v26
    v_cvt_pk_bf16_f32 v25, v25, v25
    v_lshlrev_b32 v25, 16, v25
    v_add_f32 v24, v24, v25
    v_cvt_pk_bf16_f32 v24, v24, v24
    v_lshlrev_b32 v24, 16, v24
    v_cvt_pk_bf16_f32 v78, v78, v78
    v_lshlrev_b32 v78, 16, v78
    v_add_f32 v30, v24, v78
    v_and_b32 v24, 0xffff0000, v177
    v_and_b32 v25, 0xffff0000, v179
    v_lshlrev_b32 v26, 16, v183
    v_mul_f32 v25, v25, v26
    v_cvt_pk_bf16_f32 v25, v25, v25
    v_lshlrev_b32 v25, 16, v25
    v_add_f32 v24, v24, v25
    v_cvt_pk_bf16_f32 v24, v24, v24
    v_lshlrev_b32 v24, 16, v24
    v_cvt_pk_bf16_f32 v79, v79, v79
    v_lshlrev_b32 v79, 16, v79
    v_add_f32 v31, v24, v79
    v_cvt_pk_bf16_f32 v26, v28, v29
    v_cvt_pk_bf16_f32 v27, v30, v31
    buffer_store_dwordx2 v[26:27], v8, s[28:31], 0 offen offset:16
    s_waitcnt vmcnt(32)
    v_lshlrev_b32 v24, 16, v184
    v_lshlrev_b32 v25, 16, v186
    v_lshlrev_b32 v26, 16, v188
    v_mul_f32 v25, v25, v26
    v_cvt_pk_bf16_f32 v25, v25, v25
    v_lshlrev_b32 v25, 16, v25
    v_add_f32 v24, v24, v25
    v_cvt_pk_bf16_f32 v24, v24, v24
    v_lshlrev_b32 v24, 16, v24
    v_cvt_pk_bf16_f32 v80, v80, v80
    v_lshlrev_b32 v80, 16, v80
    v_add_f32 v28, v24, v80
    v_and_b32 v24, 0xffff0000, v184
    v_and_b32 v25, 0xffff0000, v186
    v_lshlrev_b32 v26, 16, v189
    v_mul_f32 v25, v25, v26
    v_cvt_pk_bf16_f32 v25, v25, v25
    v_lshlrev_b32 v25, 16, v25
    v_add_f32 v24, v24, v25
    v_cvt_pk_bf16_f32 v24, v24, v24
    v_lshlrev_b32 v24, 16, v24
    v_cvt_pk_bf16_f32 v81, v81, v81
    v_lshlrev_b32 v81, 16, v81
    v_add_f32 v29, v24, v81
    v_lshlrev_b32 v24, 16, v185
    v_lshlrev_b32 v25, 16, v187
    v_lshlrev_b32 v26, 16, v190
    v_mul_f32 v25, v25, v26
    v_cvt_pk_bf16_f32 v25, v25, v25
    v_lshlrev_b32 v25, 16, v25
    v_add_f32 v24, v24, v25
    v_cvt_pk_bf16_f32 v24, v24, v24
    v_lshlrev_b32 v24, 16, v24
    v_cvt_pk_bf16_f32 v82, v82, v82
    v_lshlrev_b32 v82, 16, v82
    v_add_f32 v30, v24, v82
    v_and_b32 v24, 0xffff0000, v185
    v_and_b32 v25, 0xffff0000, v187
    v_lshlrev_b32 v26, 16, v191
    v_mul_f32 v25, v25, v26
    v_cvt_pk_bf16_f32 v25, v25, v25
    v_lshlrev_b32 v25, 16, v25
    v_add_f32 v24, v24, v25
    v_cvt_pk_bf16_f32 v24, v24, v24
    v_lshlrev_b32 v24, 16, v24
    v_cvt_pk_bf16_f32 v83, v83, v83
    v_lshlrev_b32 v83, 16, v83
    v_add_f32 v31, v24, v83
    v_cvt_pk_bf16_f32 v26, v28, v29
    v_cvt_pk_bf16_f32 v27, v30, v31
    buffer_store_dwordx2 v[26:27], v8, s[28:31], 0 offen offset:32
    s_waitcnt vmcnt(27)
    v_lshlrev_b32 v24, 16, v192
    v_lshlrev_b32 v25, 16, v194
    v_lshlrev_b32 v26, 16, v196
    v_mul_f32 v25, v25, v26
    v_cvt_pk_bf16_f32 v25, v25, v25
    v_lshlrev_b32 v25, 16, v25
    v_add_f32 v24, v24, v25
    v_cvt_pk_bf16_f32 v24, v24, v24
    v_lshlrev_b32 v24, 16, v24
    v_cvt_pk_bf16_f32 v84, v84, v84
    v_lshlrev_b32 v84, 16, v84
    v_add_f32 v28, v24, v84
    v_and_b32 v24, 0xffff0000, v192
    v_and_b32 v25, 0xffff0000, v194
    v_lshlrev_b32 v26, 16, v197
    v_mul_f32 v25, v25, v26
    v_cvt_pk_bf16_f32 v25, v25, v25
    v_lshlrev_b32 v25, 16, v25
    v_add_f32 v24, v24, v25
    v_cvt_pk_bf16_f32 v24, v24, v24
    v_lshlrev_b32 v24, 16, v24
    v_cvt_pk_bf16_f32 v85, v85, v85
    v_lshlrev_b32 v85, 16, v85
    v_add_f32 v29, v24, v85
    v_lshlrev_b32 v24, 16, v193
    v_lshlrev_b32 v25, 16, v195
    v_lshlrev_b32 v26, 16, v198
    v_mul_f32 v25, v25, v26
    v_cvt_pk_bf16_f32 v25, v25, v25
    v_lshlrev_b32 v25, 16, v25
    v_add_f32 v24, v24, v25
    v_cvt_pk_bf16_f32 v24, v24, v24
    v_lshlrev_b32 v24, 16, v24
    v_cvt_pk_bf16_f32 v86, v86, v86
    v_lshlrev_b32 v86, 16, v86
    v_add_f32 v30, v24, v86
    v_and_b32 v24, 0xffff0000, v193
    v_and_b32 v25, 0xffff0000, v195
    v_lshlrev_b32 v26, 16, v199
    v_mul_f32 v25, v25, v26
    v_cvt_pk_bf16_f32 v25, v25, v25
    v_lshlrev_b32 v25, 16, v25
    v_add_f32 v24, v24, v25
    v_cvt_pk_bf16_f32 v24, v24, v24
    v_lshlrev_b32 v24, 16, v24
    v_cvt_pk_bf16_f32 v87, v87, v87
    v_lshlrev_b32 v87, 16, v87
    v_add_f32 v31, v24, v87
    v_cvt_pk_bf16_f32 v26, v28, v29
    v_cvt_pk_bf16_f32 v27, v30, v31
    buffer_store_dwordx2 v[26:27], v8, s[28:31], 0 offen offset:48
    s_waitcnt vmcnt(22)
    v_lshlrev_b32 v24, 16, v200
    v_lshlrev_b32 v25, 16, v202
    v_lshlrev_b32 v26, 16, v204
    v_mul_f32 v25, v25, v26
    v_cvt_pk_bf16_f32 v25, v25, v25
    v_lshlrev_b32 v25, 16, v25
    v_add_f32 v24, v24, v25
    v_cvt_pk_bf16_f32 v24, v24, v24
    v_lshlrev_b32 v24, 16, v24
    v_cvt_pk_bf16_f32 v88, v88, v88
    v_lshlrev_b32 v88, 16, v88
    v_add_f32 v28, v24, v88
    v_and_b32 v24, 0xffff0000, v200
    v_and_b32 v25, 0xffff0000, v202
    v_lshlrev_b32 v26, 16, v205
    v_mul_f32 v25, v25, v26
    v_cvt_pk_bf16_f32 v25, v25, v25
    v_lshlrev_b32 v25, 16, v25
    v_add_f32 v24, v24, v25
    v_cvt_pk_bf16_f32 v24, v24, v24
    v_lshlrev_b32 v24, 16, v24
    v_cvt_pk_bf16_f32 v89, v89, v89
    v_lshlrev_b32 v89, 16, v89
    v_add_f32 v29, v24, v89
    v_lshlrev_b32 v24, 16, v201
    v_lshlrev_b32 v25, 16, v203
    v_lshlrev_b32 v26, 16, v206
    v_mul_f32 v25, v25, v26
    v_cvt_pk_bf16_f32 v25, v25, v25
    v_lshlrev_b32 v25, 16, v25
    v_add_f32 v24, v24, v25
    v_cvt_pk_bf16_f32 v24, v24, v24
    v_lshlrev_b32 v24, 16, v24
    v_cvt_pk_bf16_f32 v90, v90, v90
    v_lshlrev_b32 v90, 16, v90
    v_add_f32 v30, v24, v90
    v_and_b32 v24, 0xffff0000, v201
    v_and_b32 v25, 0xffff0000, v203
    v_lshlrev_b32 v26, 16, v207
    v_mul_f32 v25, v25, v26
    v_cvt_pk_bf16_f32 v25, v25, v25
    v_lshlrev_b32 v25, 16, v25
    v_add_f32 v24, v24, v25
    v_cvt_pk_bf16_f32 v24, v24, v24
    v_lshlrev_b32 v24, 16, v24
    v_cvt_pk_bf16_f32 v91, v91, v91
    v_lshlrev_b32 v91, 16, v91
    v_add_f32 v31, v24, v91
    v_cvt_pk_bf16_f32 v26, v28, v29
    v_cvt_pk_bf16_f32 v27, v30, v31
    buffer_store_dwordx2 v[26:27], v8, s[28:31], 0 offen offset:64
    s_waitcnt vmcnt(17)
    v_lshlrev_b32 v24, 16, v208
    v_lshlrev_b32 v25, 16, v210
    v_lshlrev_b32 v26, 16, v212
    v_mul_f32 v25, v25, v26
    v_cvt_pk_bf16_f32 v25, v25, v25
    v_lshlrev_b32 v25, 16, v25
    v_add_f32 v24, v24, v25
    v_cvt_pk_bf16_f32 v24, v24, v24
    v_lshlrev_b32 v24, 16, v24
    v_cvt_pk_bf16_f32 v92, v92, v92
    v_lshlrev_b32 v92, 16, v92
    v_add_f32 v28, v24, v92
    v_and_b32 v24, 0xffff0000, v208
    v_and_b32 v25, 0xffff0000, v210
    v_lshlrev_b32 v26, 16, v213
    v_mul_f32 v25, v25, v26
    v_cvt_pk_bf16_f32 v25, v25, v25
    v_lshlrev_b32 v25, 16, v25
    v_add_f32 v24, v24, v25
    v_cvt_pk_bf16_f32 v24, v24, v24
    v_lshlrev_b32 v24, 16, v24
    v_cvt_pk_bf16_f32 v93, v93, v93
    v_lshlrev_b32 v93, 16, v93
    v_add_f32 v29, v24, v93
    v_lshlrev_b32 v24, 16, v209
    v_lshlrev_b32 v25, 16, v211
    v_lshlrev_b32 v26, 16, v214
    v_mul_f32 v25, v25, v26
    v_cvt_pk_bf16_f32 v25, v25, v25
    v_lshlrev_b32 v25, 16, v25
    v_add_f32 v24, v24, v25
    v_cvt_pk_bf16_f32 v24, v24, v24
    v_lshlrev_b32 v24, 16, v24
    v_cvt_pk_bf16_f32 v94, v94, v94
    v_lshlrev_b32 v94, 16, v94
    v_add_f32 v30, v24, v94
    v_and_b32 v24, 0xffff0000, v209
    v_and_b32 v25, 0xffff0000, v211
    v_lshlrev_b32 v26, 16, v215
    v_mul_f32 v25, v25, v26
    v_cvt_pk_bf16_f32 v25, v25, v25
    v_lshlrev_b32 v25, 16, v25
    v_add_f32 v24, v24, v25
    v_cvt_pk_bf16_f32 v24, v24, v24
    v_lshlrev_b32 v24, 16, v24
    v_cvt_pk_bf16_f32 v95, v95, v95
    v_lshlrev_b32 v95, 16, v95
    v_add_f32 v31, v24, v95
    v_cvt_pk_bf16_f32 v26, v28, v29
    v_cvt_pk_bf16_f32 v27, v30, v31
    buffer_store_dwordx2 v[26:27], v8, s[28:31], 0 offen offset:80
    s_waitcnt vmcnt(12)
    v_lshlrev_b32 v24, 16, v216
    v_lshlrev_b32 v25, 16, v218
    v_lshlrev_b32 v26, 16, v220
    v_mul_f32 v25, v25, v26
    v_cvt_pk_bf16_f32 v25, v25, v25
    v_lshlrev_b32 v25, 16, v25
    v_add_f32 v24, v24, v25
    v_cvt_pk_bf16_f32 v24, v24, v24
    v_lshlrev_b32 v24, 16, v24
    v_cvt_pk_bf16_f32 v96, v96, v96
    v_lshlrev_b32 v96, 16, v96
    v_add_f32 v28, v24, v96
    v_and_b32 v24, 0xffff0000, v216
    v_and_b32 v25, 0xffff0000, v218
    v_lshlrev_b32 v26, 16, v221
    v_mul_f32 v25, v25, v26
    v_cvt_pk_bf16_f32 v25, v25, v25
    v_lshlrev_b32 v25, 16, v25
    v_add_f32 v24, v24, v25
    v_cvt_pk_bf16_f32 v24, v24, v24
    v_lshlrev_b32 v24, 16, v24
    v_cvt_pk_bf16_f32 v97, v97, v97
    v_lshlrev_b32 v97, 16, v97
    v_add_f32 v29, v24, v97
    v_lshlrev_b32 v24, 16, v217
    v_lshlrev_b32 v25, 16, v219
    v_lshlrev_b32 v26, 16, v222
    v_mul_f32 v25, v25, v26
    v_cvt_pk_bf16_f32 v25, v25, v25
    v_lshlrev_b32 v25, 16, v25
    v_add_f32 v24, v24, v25
    v_cvt_pk_bf16_f32 v24, v24, v24
    v_lshlrev_b32 v24, 16, v24
    v_cvt_pk_bf16_f32 v98, v98, v98
    v_lshlrev_b32 v98, 16, v98
    v_add_f32 v30, v24, v98
    v_and_b32 v24, 0xffff0000, v217
    v_and_b32 v25, 0xffff0000, v219
    v_lshlrev_b32 v26, 16, v223
    v_mul_f32 v25, v25, v26
    v_cvt_pk_bf16_f32 v25, v25, v25
    v_lshlrev_b32 v25, 16, v25
    v_add_f32 v24, v24, v25
    v_cvt_pk_bf16_f32 v24, v24, v24
    v_lshlrev_b32 v24, 16, v24
    v_cvt_pk_bf16_f32 v99, v99, v99
    v_lshlrev_b32 v99, 16, v99
    v_add_f32 v31, v24, v99
    v_cvt_pk_bf16_f32 v26, v28, v29
    v_cvt_pk_bf16_f32 v27, v30, v31
    buffer_store_dwordx2 v[26:27], v8, s[28:31], 0 offen offset:96
    s_waitcnt vmcnt(7)
    v_lshlrev_b32 v24, 16, v224
    v_lshlrev_b32 v25, 16, v226
    v_lshlrev_b32 v26, 16, v228
    v_mul_f32 v25, v25, v26
    v_cvt_pk_bf16_f32 v25, v25, v25
    v_lshlrev_b32 v25, 16, v25
    v_add_f32 v24, v24, v25
    v_cvt_pk_bf16_f32 v24, v24, v24
    v_lshlrev_b32 v24, 16, v24
    v_cvt_pk_bf16_f32 v100, v100, v100
    v_lshlrev_b32 v100, 16, v100
    v_add_f32 v28, v24, v100
    v_and_b32 v24, 0xffff0000, v224
    v_and_b32 v25, 0xffff0000, v226
    v_lshlrev_b32 v26, 16, v229
    v_mul_f32 v25, v25, v26
    v_cvt_pk_bf16_f32 v25, v25, v25
    v_lshlrev_b32 v25, 16, v25
    v_add_f32 v24, v24, v25
    v_cvt_pk_bf16_f32 v24, v24, v24
    v_lshlrev_b32 v24, 16, v24
    v_cvt_pk_bf16_f32 v101, v101, v101
    v_lshlrev_b32 v101, 16, v101
    v_add_f32 v29, v24, v101
    v_lshlrev_b32 v24, 16, v225
    v_lshlrev_b32 v25, 16, v227
    v_lshlrev_b32 v26, 16, v230
    v_mul_f32 v25, v25, v26
    v_cvt_pk_bf16_f32 v25, v25, v25
    v_lshlrev_b32 v25, 16, v25
    v_add_f32 v24, v24, v25
    v_cvt_pk_bf16_f32 v24, v24, v24
    v_lshlrev_b32 v24, 16, v24
    v_cvt_pk_bf16_f32 v102, v102, v102
    v_lshlrev_b32 v102, 16, v102
    v_add_f32 v30, v24, v102
    v_and_b32 v24, 0xffff0000, v225
    v_and_b32 v25, 0xffff0000, v227
    v_lshlrev_b32 v26, 16, v231
    v_mul_f32 v25, v25, v26
    v_cvt_pk_bf16_f32 v25, v25, v25
    v_lshlrev_b32 v25, 16, v25
    v_add_f32 v24, v24, v25
    v_cvt_pk_bf16_f32 v24, v24, v24
    v_lshlrev_b32 v24, 16, v24
    v_cvt_pk_bf16_f32 v103, v103, v103
    v_lshlrev_b32 v103, 16, v103
    v_add_f32 v31, v24, v103
    v_cvt_pk_bf16_f32 v26, v28, v29
    v_cvt_pk_bf16_f32 v27, v30, v31
    buffer_store_dwordx2 v[26:27], v8, s[28:31], 0 offen offset:112
gemm2_end:
    s_endpgm
.section .rodata,"a"
.p2align 6
.amdhsa_kernel gemm2_kernel
  .amdhsa_next_free_vgpr 232
  .amdhsa_next_free_sgpr 64
  .amdhsa_accum_offset 232
  .amdhsa_group_segment_fixed_size 0
  .amdhsa_kernarg_size 104
  .amdhsa_user_sgpr_count 2
  .amdhsa_user_sgpr_kernarg_segment_ptr 1
  .amdhsa_system_sgpr_workgroup_id_x 1
.end_amdhsa_kernel
.text
```
